```python
import torch

def _softmax(x, axis=-1):
    return torch.softmax(x, dim=axis)
def _gelu(x):
    return torch.nn.functional.gelu(x, approximate="tanh")
def _silu(x):
    return torch.nn.functional.silu(x)
def _sigmoid(x):
    return torch.sigmoid(x)
def _layernorm(x, axis=-1, eps=1e-5):
    m = x.mean(dim=axis, keepdim=True)
    v = x.var(dim=axis, keepdim=True, unbiased=False)
    return (x - m) / torch.sqrt(v + eps)
def _scatter_add(tgt, idx, src, axis=0):
    return tgt.clone().index_add_(axis, idx, src)
def _segment_sum(src, seg, n):
    out = torch.zeros((n,) + src.shape[1:], dtype=src.dtype)
    return out.index_add_(0, seg, src)
def _pad(x, pw):
    flat = tuple(v for pair in reversed(pw) for v in pair)
    return torch.nn.functional.pad(x, flat)

kernel_name = 'standalone__mixer_token_mlp__sampling'

def setup_inputs():

    _w = (lambda a: (lambda t: t.to(torch.bfloat16) if t.is_floating_point() else t)(torch.as_tensor(a)))
    B, S, D, F = 32, 32, 576, 4608
    return {
        "x": _w((lambda *s: torch.randn(*s, dtype=torch.bfloat16) * 0.05)(B, S, D)),
        "w1": _w((lambda *s: torch.randn(*s, dtype=torch.bfloat16) * 0.2)(S, F) * (S ** -0.5)),
        "b1": _w((lambda *s: torch.randn(*s, dtype=torch.bfloat16) * 3.2)(F) * 0.02),
        "w2": _w((lambda *s: torch.randn(*s, dtype=torch.bfloat16) * 0.05)(F, S) * (F ** -0.5)),
        "b2": _w((lambda *s: torch.randn(*s, dtype=torch.bfloat16) * 0.1)(S) * 0.02),
    }

def reference(x, w1, b1, w2, b2):
    B, S, D = x.shape
    h = _layernorm(x, axis=-1)
    u = torch.einsum("bsd,sf->bdf", h, w1) + b1
    u = _gelu(u)
    y = torch.einsum("bdf,fs->bds", u, w2) + b2
    return (lambda x, *d: x.permute(*d))(y, 0, 2, 1)
```

```asm
; @launch grid=(256,1,1) block=(512,1,1) lds=163840
.amdgcn_target "amdgcn-amd-amdhsa--gfx950"
.text
.globl standalone__mixer_token_mlp__sampling_kernel
.p2align 8
.type standalone__mixer_token_mlp__sampling_kernel,@function
standalone__mixer_token_mlp__sampling_kernel:
    s_cmp_ge_u32 s2, 256
    s_cbranch_scc1 L_done
    s_load_dwordx16 s[4:19], s[0:1], 0
    v_lshrrev_b32_e32 v224, 6, v0
    v_and_b32_e32 v1, 63, v0
    v_readfirstlane_b32 s54, v224
    s_and_b32 s67, s2, 7
    s_lshr_b32 s68, s2, 3
    s_lshr_b32 s69, s68, 3
    s_lshl_b32 s55, s67, 2
    s_add_u32 s55, s55, s69
    s_and_b32 s56, s68, 7
    s_and_b32 s63, s54, 3
    s_cmp_lt_u32 s54, 4
    s_cbranch_scc1 L_proL
    s_setprio 2
    s_mul_i32 s71, s55, 36864
    s_mul_i32 s67, s63, 9216
    s_add_u32 s71, s71, s67
    v_lshrrev_b32_e32 v230, 3, v1
    v_and_b32_e32 v231, 7, v1
    v_mul_u32_u24_e32 v233, 1152, v230
    v_lshl_add_u32 v232, v231, 4, v233
    v_lshl_add_u32 v233, v231, 3, v233
    s_lshl_b32 s67, s56, 7
    s_add_u32 s59, s71, s67
    s_add_u32 s60, s71, 1152
    s_lshr_b32 s52, s56, 2
    s_lshl_b32 s52, s52, 6
    s_add_u32 s52, s52, s71
    s_and_b32 s66, s56, 3
    s_lshl_b32 s64, s54, 13
    s_add_u32 s65, s64, 4096
    v_lshrrev_b32_e32 v224, 3, v1
    v_lshrrev_b32_e32 v225, 2, v1
    v_and_b32_e32 v225, 4, v225
    v_and_b32_e32 v8, 7, v1
    v_xor_b32_e32 v225, v225, v8
    v_mul_u32_u24_e32 v4, 9216, v224
    v_lshl_add_u32 v4, v225, 4, v4
    v_add_u32_e32 v5, 72704, v4
    v_add_u32_e32 v6, 145408, v4
    v_add_u32_e32 v7, 218112, v4
    v_lshlrev_b32_e32 v8, 4, v1
    v_and_b32_e32 v9, 31, v1
    v_lshlrev_b32_e32 v9, 1, v9
    s_mul_i32 s69, s66, 9
    v_min_u32_e32 v11, 16, v1
    v_sub_u32_e32 v224, 0, v11
    s_bitcmp1_b32 s66, 0
    s_cselect_b32 s70, 9, 35
    s_cselect_b64 vcc, -1, 0
    s_add_u32 s69, s69, s70
    v_cndmask_b32_e32 v11, v224, v11, vcc
    v_add_u32_e32 v11, s69, v11
    v_subrev_u32_e32 v224, 36, v11
    v_min_u32_e32 v11, v11, v224
    s_mul_i32 s69, s63, 2304
    v_lshl_add_u32 v11, v11, 6, s69
    s_mov_b32 s48, 0xc09d30fc
    s_mov_b32 s50, 0x3eef48bf
    s_mov_b32 s49, 0xc09d30fc
    s_mov_b32 s51, 0x3eef48bf
    v_and_b32_e32 v225, 3, v1
    v_lshlrev_b32_e32 v225, 3, v225
    v_bfe_u32 v224, v1, 4, 1
    v_lshl_add_u32 v225, v224, 5, v225
    v_bfe_u32 v224, v1, 2, 2
    v_lshrrev_b32_e32 v227, 5, v1
    v_lshl_add_u32 v224, v227, 2, v224
    v_lshl_add_u32 v10, v224, 6, v225
    v_lshl_add_u32 v2, v224, 7, v225
    v_bfe_u32 v224, v1, 3, 1
    v_lshl_add_u32 v2, v224, 6, v2
    s_bitcmp1_b32 s66, 0
    s_cselect_b32 s69, 0, 64
    s_add_u32 s69, s69, s64
    v_xor_b32_e32 v2, s69, v2
    v_lshl_add_u32 v3, v227, 8, v10
    v_add_u32_e32 v3, s65, v3
    v_mov_b32_e32 v12, 0xdddddddd
    v_cmp_le_u32_e32 vcc, 32, v1
    v_mov_b32_e32 v20, 0x3ef0
    v_mov_b32_e32 v227, 0xb8ab
    v_cndmask_b32_e32 v20, v20, v227, vcc
    v_mov_b32_e32 v26, 0
    v_mov_b32_e32 v27, 0
    v_mov_b32_e32 v28, 0
    v_mov_b32_e32 v29, 0
    v_mov_b32_e32 v21, 0
    v_mov_b32_e32 v23, 0
    v_mov_b32_e32 v24, 0
    v_mov_b32_e32 v25, 0
    v_readlane_b32 s57, v11, 0
    v_mov_b32_e32 v226, 0x3f803f80
    v_mfma_f32_32x32x16_bf16 v[40:55], v[26:29], v[26:29], 0
    v_mfma_f32_32x32x16_bf16 v[56:71], v[26:29], v[26:29], 0
    v_mfma_f32_32x32x16_bf16 v[112:127], v[26:29], v[26:29], 0
    v_mfma_f32_32x32x16_bf16 v[208:223], v[26:29], v[26:29], 0
    v_mfma_f32_32x32x16_bf16 v[72:87], v[26:29], v[26:29], 0
    s_lshl_b32 s67, s63, 9
    v_lshl_add_u32 v228, v230, 6, s67
    v_and_b32_e32 v227, 3, v231
    v_lshl_add_u32 v227, v227, 4, v228
    v_lshrrev_b32_e32 v229, 2, v231
    v_lshl_add_u32 v227, v229, 13, v227
    v_lshl_add_u32 v228, v231, 3, v228
    s_and_b32 s61, s57, 0xffffff80
    s_lshl_b32 s58, s57, 5
    s_waitcnt lgkmcnt(0)
    s_mov_b32 s20, s4
    s_and_b32 s21, s5, 0xffff
    s_mov_b32 s22, 1179648
    s_mov_b32 s23, 0x20000
    buffer_load_dwordx4 v[144:147], v232, s[20:23], s59 offen
    buffer_load_dwordx2 v[180:181], v233, s[20:23], s52 offen offset:1024
    s_add_u32 s59, s59, 128
    s_cmp_eq_u32 s59, s60
    s_cselect_b32 s59, s71, s59
    buffer_load_dwordx4 v[148:151], v232, s[20:23], s59 offen
    s_add_u32 s59, s59, 128
    s_cmp_eq_u32 s59, s60
    s_cselect_b32 s59, s71, s59
    buffer_load_dwordx4 v[152:155], v232, s[20:23], s59 offen
    s_add_u32 s59, s59, 128
    s_cmp_eq_u32 s59, s60
    s_cselect_b32 s59, s71, s59
    buffer_load_dwordx4 v[156:159], v232, s[20:23], s59 offen
    s_add_u32 s59, s59, 128
    s_cmp_eq_u32 s59, s60
    s_cselect_b32 s59, s71, s59
    buffer_load_dwordx4 v[160:163], v232, s[20:23], s59 offen
    s_add_u32 s59, s59, 128
    s_cmp_eq_u32 s59, s60
    s_cselect_b32 s59, s71, s59
    buffer_load_dwordx4 v[164:167], v232, s[20:23], s59 offen
    s_add_u32 s59, s59, 128
    s_cmp_eq_u32 s59, s60
    s_cselect_b32 s59, s71, s59
    buffer_load_dwordx4 v[168:171], v232, s[20:23], s59 offen
    s_add_u32 s59, s59, 128
    s_cmp_eq_u32 s59, s60
    s_cselect_b32 s59, s71, s59
    buffer_load_dwordx4 v[172:175], v232, s[20:23], s59 offen
    s_add_u32 s59, s59, 128
    s_cmp_eq_u32 s59, s60
    s_cselect_b32 s59, s71, s59
    buffer_load_dwordx4 v[176:179], v232, s[20:23], s59 offen
    s_mov_b32 s32, s8
    s_and_b32 s33, s9, 0xffff
    s_mov_b32 s34, 9216
    s_mov_b32 s35, 0x20000
    s_mov_b32 s24, s6
    s_and_b32 s25, s7, 0xffff
    s_mov_b32 s26, 294912
    s_mov_b32 s27, 0x20000
    s_mov_b32 s28, s10
    s_and_b32 s29, s11, 0xffff
    s_mov_b32 s30, 294912
    s_mov_b32 s31, 0x20000
    s_mov_b32 s36, s12
    s_and_b32 s37, s13, 0xffff
    s_mov_b32 s38, 64
    s_mov_b32 s39, 0x20000
    s_mov_b32 s40, s14
    s_and_b32 s41, s15, 0xffff
    s_mov_b32 s42, 1179648
    s_mov_b32 s43, 0x20000
    s_lshl_b32 s69, s63, 4
    s_mov_b32 m0, s64
    s_lshl_b32 s99, s54, 10
    v_lshl_add_u32 v15, v1, 4, s99
    v_xor_b32_e32 v16, 4096, v15
    v_bfe_u32 v229, v1, 3, 1
    v_lshrrev_b32_e32 v32, 4, v1
    v_lshl_add_u32 v32, v229, 2, v32
    v_and_b32_e32 v229, 7, v1
    v_mul_u32_u24_e32 v18, 1152, v32
    v_lshl_add_u32 v18, v229, 3, v18
    v_lshlrev_b32_e32 v32, 1, v32
    v_lshlrev_b32_e32 v17, 2, v1
    v_mov_b32_e32 v30, 0
    s_mul_i32 s99, s55, 36864
    s_mul_i32 s101, s63, 9216
    s_add_u32 s99, s99, s101
    s_lshr_b32 s101, s56, 2
    s_lshl_b32 s101, s101, 6
    s_add_u32 s101, s101, s99
    s_add_u32 s101, s101, 1024
    s_lshl_b32 s67, s56, 7
    s_add_u32 s99, s99, s67
    s_lshr_b32 s67, s54, 2
    s_lshl_b32 s67, s67, 6
    s_add_u32 s99, s99, s67
    s_branch L_proV2
L_proL:
    s_mov_b32 s48, 0xc09d30fc
    s_mov_b32 s50, 0x3eeff558
    s_mov_b32 s49, 0xc09d30fc
    s_mov_b32 s51, 0x3eeff558
    s_mov_b32 s52, 0x3f888e99
    s_mov_b32 s53, 0x3f888e99
    s_mov_b32 s62, 0x08000800
    s_lshl_b32 s67, s54, 9
    s_add_u32 s67, s67, 128
    v_lshl_add_u32 v230, v1, 3, s67
    v_lshlrev_b32_e32 v231, 16, v230
    v_add_u32_e32 v144, 0x8000, v231
    v_add_u32_e32 v145, 0x18000, v231
    v_add_u32_e32 v146, 0x28000, v231
    v_add_u32_e32 v147, 0x38000, v231
    v_add_u32_e32 v148, 0x48000, v231
    v_add_u32_e32 v149, 0x58000, v231
    v_add_u32_e32 v150, 0x68000, v231
    v_add_u32_e32 v151, 0x78000, v231
    v_pk_mul_f32 v[152:153], v[144:145], s[52:53]
    v_pk_mul_f32 v[154:155], v[146:147], s[52:53]
    v_pk_mul_f32 v[156:157], v[148:149], s[52:53]
    v_pk_mul_f32 v[158:159], v[150:151], s[52:53]
    v_cvt_pk_bf16_f32 v160, v152, v153
    v_cvt_pk_bf16_f32 v161, v154, v155
    v_cvt_pk_bf16_f32 v162, v156, v157
    v_cvt_pk_bf16_f32 v163, v158, v159
    v_lshlrev_b32_e32 v230, 1, v230
    v_add_u32_e32 v230, 65280, v230
    v_add_u32_e32 v231, 49152, v230
    ds_write_b128 v230, v[160:163] offset:0
    v_add_u32_e32 v164, s62, v160
    v_add_u32_e32 v165, s62, v161
    v_add_u32_e32 v166, s62, v162
    v_add_u32_e32 v167, s62, v163
    v_mov_b32_e32 v232, 0x7f807f80
    v_cmp_gt_u32_e32 vcc, 48, v1
    s_cmp_eq_u32 s54, 3
    s_cselect_b32 s70, 0, -1
    v_cndmask_b32_e32 v232, 0, v232, vcc
    v_or_b32_e32 v232, s70, v232
    ds_write_b128 v230, v[164:167] offset:4096
    v_add_u32_e32 v160, s62, v164
    v_add_u32_e32 v161, s62, v165
    v_add_u32_e32 v162, s62, v166
    v_add_u32_e32 v163, s62, v167
    s_and_b32 s66, s56, 3
    s_lshl_b32 s64, s54, 13
    s_add_u32 s65, s64, 4096
    v_lshrrev_b32_e32 v224, 3, v1
    v_lshrrev_b32_e32 v225, 2, v1
    v_and_b32_e32 v225, 4, v225
    ds_write_b128 v230, v[160:163] offset:8192
    v_add_u32_e32 v164, s62, v160
    v_add_u32_e32 v165, s62, v161
    v_add_u32_e32 v166, s62, v162
    v_add_u32_e32 v167, s62, v163
    v_and_b32_e32 v8, 7, v1
    v_xor_b32_e32 v225, v225, v8
    v_mul_u32_u24_e32 v4, 9216, v224
    v_lshl_add_u32 v4, v225, 4, v4
    v_add_u32_e32 v5, 72704, v4
    v_add_u32_e32 v6, 145408, v4
    ds_write_b128 v230, v[164:167] offset:12288
    v_add_u32_e32 v160, s62, v164
    v_add_u32_e32 v161, s62, v165
    v_add_u32_e32 v162, s62, v166
    v_add_u32_e32 v163, s62, v167
    v_add_u32_e32 v7, 218112, v4
    v_lshlrev_b32_e32 v8, 4, v1
    v_and_b32_e32 v9, 31, v1
    v_lshlrev_b32_e32 v9, 1, v9
    s_mul_i32 s69, s66, 9
    v_min_u32_e32 v11, 19, v1
    ds_write_b128 v230, v[160:163] offset:16384
    v_add_u32_e32 v164, s62, v160
    v_add_u32_e32 v165, s62, v161
    v_add_u32_e32 v166, s62, v162
    v_add_u32_e32 v167, s62, v163
    v_sub_u32_e32 v224, 0, v11
    s_bitcmp1_b32 s66, 0
    s_cselect_b32 s70, 44, 0
    s_cselect_b64 vcc, 0, -1
    s_add_u32 s69, s69, s70
    v_cndmask_b32_e32 v11, v224, v11, vcc
    ds_write_b128 v230, v[164:167] offset:20480
    v_add_u32_e32 v160, s62, v164
    v_add_u32_e32 v161, s62, v165
    v_add_u32_e32 v162, s62, v166
    v_add_u32_e32 v163, s62, v167
    v_add_u32_e32 v11, s69, v11
    v_subrev_u32_e32 v224, 36, v11
    v_min_u32_e32 v11, v11, v224
    s_mul_i32 s69, s63, 2304
    v_lshl_add_u32 v11, v11, 6, s69
    v_and_b32_e32 v225, 3, v1
    ds_write_b128 v230, v[160:163] offset:24576
    v_add_u32_e32 v164, 0x10801080, v160
    v_add_u32_e32 v165, 0x10801080, v161
    v_add_u32_e32 v166, 0x10801080, v162
    v_add_u32_e32 v167, 0x10801080, v163
    v_lshlrev_b32_e32 v225, 3, v225
    v_bfe_u32 v224, v1, 4, 1
    v_lshl_add_u32 v225, v224, 5, v225
    v_bfe_u32 v224, v1, 2, 2
    v_lshrrev_b32_e32 v227, 5, v1
    v_lshl_add_u32 v224, v227, 2, v224
    v_lshl_add_u32 v10, v224, 6, v225
    v_lshl_add_u32 v2, v224, 7, v225
    v_bfe_u32 v224, v1, 3, 1
    v_lshl_add_u32 v2, v224, 6, v2
    s_bitcmp1_b32 s66, 0
    s_cselect_b32 s69, 64, 0
    ds_write_b128 v230, v[164:167] offset:32768
    v_add_u32_e32 v160, s62, v164
    v_add_u32_e32 v161, s62, v165
    v_add_u32_e32 v162, s62, v166
    v_add_u32_e32 v163, s62, v167
    s_add_u32 s69, s69, s64
    v_xor_b32_e32 v2, s69, v2
    v_lshl_add_u32 v3, v227, 8, v10
    v_add_u32_e32 v3, s65, v3
    v_mov_b32_e32 v12, 0xdddddddd
    v_cmp_le_u32_e32 vcc, 32, v1
    ds_write_b128 v230, v[160:163] offset:36864
    v_add_u32_e32 v164, s62, v160
    v_add_u32_e32 v165, s62, v161
    v_add_u32_e32 v166, s62, v162
    v_add_u32_e32 v167, s62, v163
    v_mov_b32_e32 v20, 0x3ef0
    v_mov_b32_e32 v227, 0xb8ab
    v_cndmask_b32_e32 v20, v20, v227, vcc
    v_mov_b32_e32 v26, 0
    v_mov_b32_e32 v27, 0
    v_mov_b32_e32 v28, 0
    ds_write_b128 v230, v[164:167] offset:40960
    v_add_u32_e32 v160, s62, v164
    v_add_u32_e32 v161, s62, v165
    v_add_u32_e32 v162, s62, v166
    v_add_u32_e32 v163, s62, v167
    v_mov_b32_e32 v29, 0
    v_mov_b32_e32 v21, 0
    v_mov_b32_e32 v23, 0
    v_mov_b32_e32 v24, 0
    v_mov_b32_e32 v25, 0
    v_add_u32_e32 v144, 0x38000000, v144
    ds_write_b128 v230, v[160:163] offset:45056
    v_add_u32_e32 v164, s62, v160
    v_add_u32_e32 v165, s62, v161
    v_add_u32_e32 v166, s62, v162
    v_add_u32_e32 v167, s62, v163
    v_add_u32_e32 v145, 0x38000000, v145
    v_add_u32_e32 v146, 0x38000000, v146
    v_add_u32_e32 v147, 0x38000000, v147
    v_add_u32_e32 v148, 0x38000000, v148
    v_add_u32_e32 v149, 0x38000000, v149
    v_add_u32_e32 v150, 0x38000000, v150
    ds_write_b128 v231, v[164:167] offset:0
    v_add_u32_e32 v160, s62, v164
    v_add_u32_e32 v161, s62, v165
    v_add_u32_e32 v162, s62, v166
    v_add_u32_e32 v163, s62, v167
    v_add_u32_e32 v151, 0x38000000, v151
    v_pk_fma_f32 v[152:153], v[144:145], v[144:145], s[48:49] neg_lo:[1,0,0] neg_hi:[1,0,0]
    v_pk_fma_f32 v[154:155], v[146:147], v[146:147], s[48:49] neg_lo:[1,0,0] neg_hi:[1,0,0]
    v_pk_fma_f32 v[156:157], v[148:149], v[148:149], s[48:49] neg_lo:[1,0,0] neg_hi:[1,0,0]
    v_pk_fma_f32 v[158:159], v[150:151], v[150:151], s[48:49] neg_lo:[1,0,0] neg_hi:[1,0,0]
    v_pk_mul_f32 v[152:153], v[152:153], v[144:145]
    ds_write_b128 v231, v[160:163] offset:4096
    v_add_u32_e32 v164, s62, v160
    v_add_u32_e32 v165, s62, v161
    v_add_u32_e32 v166, s62, v162
    v_add_u32_e32 v167, s62, v163
    v_pk_mul_f32 v[154:155], v[154:155], v[146:147]
    v_pk_mul_f32 v[156:157], v[156:157], v[148:149]
    v_pk_mul_f32 v[158:159], v[158:159], v[150:151]
    v_exp_f32_e32 v152, v152
    v_exp_f32_e32 v153, v153
    v_exp_f32_e32 v154, v154
    ds_write_b128 v231, v[164:167] offset:8192
    v_add_u32_e32 v160, s62, v164
    v_add_u32_e32 v161, s62, v165
    v_add_u32_e32 v162, s62, v166
    v_add_u32_e32 v163, s62, v167
    v_exp_f32_e32 v155, v155
    v_exp_f32_e32 v156, v156
    v_exp_f32_e32 v157, v157
    v_exp_f32_e32 v158, v158
    v_exp_f32_e32 v159, v159
    v_pk_fma_f32 v[176:177], v[152:153], s[50:51], s[50:51]
    v_pk_min_u16 v184, v160, v232
    v_pk_min_u16 v185, v161, v232
    v_pk_min_u16 v186, v162, v232
    v_pk_min_u16 v187, v163, v232
    ds_write_b128 v231, v[184:187] offset:12288
    v_add_u32_e32 v164, 0x7800780, v160
    v_add_u32_e32 v165, 0x7800780, v161
    v_add_u32_e32 v166, 0x7800780, v162
    v_add_u32_e32 v167, 0x7800780, v163
    v_pk_fma_f32 v[178:179], v[154:155], s[50:51], s[50:51]
    v_pk_fma_f32 v[180:181], v[156:157], s[50:51], s[50:51]
    v_pk_fma_f32 v[182:183], v[158:159], s[50:51], s[50:51]
    v_rcp_f32_e32 v176, v176
    v_rcp_f32_e32 v177, v177
    v_rcp_f32_e32 v178, v178
    ds_write_b128 v231, v[164:167] offset:16384
    v_add_u32_e32 v160, s62, v164
    v_add_u32_e32 v161, s62, v165
    v_add_u32_e32 v162, s62, v166
    v_add_u32_e32 v163, s62, v167
    v_rcp_f32_e32 v179, v179
    v_rcp_f32_e32 v180, v180
    v_rcp_f32_e32 v181, v181
    v_rcp_f32_e32 v182, v182
    v_rcp_f32_e32 v183, v183
    v_pk_mul_f32 v[176:177], v[176:177], v[144:145]
    ds_write_b128 v231, v[160:163] offset:20480
    v_add_u32_e32 v164, s62, v160
    v_add_u32_e32 v165, s62, v161
    v_add_u32_e32 v166, s62, v162
    v_add_u32_e32 v167, s62, v163
    v_pk_mul_f32 v[178:179], v[178:179], v[146:147]
    v_pk_mul_f32 v[180:181], v[180:181], v[148:149]
    v_pk_mul_f32 v[182:183], v[182:183], v[150:151]
    v_pk_mul_f32 v[152:153], v[152:153], v[176:177] neg_lo:[1,0] neg_hi:[1,0]
    v_pk_mul_f32 v[154:155], v[154:155], v[178:179] neg_lo:[1,0] neg_hi:[1,0]
    v_pk_mul_f32 v[156:157], v[156:157], v[180:181] neg_lo:[1,0] neg_hi:[1,0]
    ds_write_b128 v231, v[164:167] offset:24576
    v_add_u32_e32 v160, s62, v164
    v_add_u32_e32 v161, s62, v165
    v_add_u32_e32 v162, s62, v166
    v_add_u32_e32 v163, s62, v167
    v_pk_mul_f32 v[158:159], v[158:159], v[182:183] neg_lo:[1,0] neg_hi:[1,0]
    v_cvt_pk_bf16_f32 v168, v176, v177
    v_cvt_pk_bf16_f32 v169, v178, v179
    v_cvt_pk_bf16_f32 v170, v180, v181
    v_cvt_pk_bf16_f32 v171, v182, v183
    v_cvt_pk_bf16_f32 v172, v152, v153
    ds_write_b128 v231, v[160:163] offset:28672
    v_add_u32_e32 v164, s62, v160
    v_add_u32_e32 v165, s62, v161
    v_add_u32_e32 v166, s62, v162
    v_add_u32_e32 v167, s62, v163
    v_cvt_pk_bf16_f32 v173, v154, v155
    v_cvt_pk_bf16_f32 v174, v156, v157
    v_cvt_pk_bf16_f32 v175, v158, v159
    ds_write_b128 v231, v[164:167] offset:32768
    v_add_u32_e32 v160, s62, v164
    v_add_u32_e32 v161, s62, v165
    v_add_u32_e32 v162, s62, v166
    v_add_u32_e32 v163, s62, v167
    ds_write_b128 v231, v[160:163] offset:36864
    v_add_u32_e32 v164, s62, v160
    v_add_u32_e32 v165, s62, v161
    v_add_u32_e32 v166, s62, v162
    v_add_u32_e32 v167, s62, v163
    s_nop 0
    v_readlane_b32 s57, v11, 0
    s_waitcnt lgkmcnt(0)
    s_mov_b32 s24, s6
    s_and_b32 s25, s7, 0xffff
    s_mov_b32 s26, 294912
    s_mov_b32 s27, 0x20000
    s_mov_b32 s28, s10
    s_and_b32 s29, s11, 0xffff
    s_mov_b32 s30, 294912
    s_mov_b32 s31, 0x20000
    s_mov_b32 s32, s8
    s_and_b32 s33, s9, 0xffff
    s_mov_b32 s34, 9216
    s_mov_b32 s35, 0x20000
    s_mov_b32 m0, s64
    s_and_b32 s61, s57, 0xffffff80
    buffer_load_dwordx4 v4, s[24:27], s61 offen offset:0 lds
    buffer_load_dwordx4 v5, s[24:27], s61 offen offset:1024 lds
    buffer_load_dwordx4 v6, s[24:27], s61 offen offset:2048 lds
    buffer_load_dwordx4 v7, s[24:27], s61 offen offset:3072 lds
    buffer_load_ushort v22, v9, s[32:35], s57 offen
    ds_write_b128 v231, v[164:167] offset:40960
    s_mov_b32 m0, s65
    s_lshl_b32 s58, s57, 5
    v_readlane_b32 s57, v11, 1
    ds_write_b128 v230, v[168:171] offset:28672
    ds_write_b128 v231, v[172:175] offset:45056
    v_lshlrev_b32_e32 v233, 2, v1
    ds_write_b32 v233, v26 offset:65280
    ds_write_b32 v233, v26 offset:64512
    v_mfma_f32_32x32x16_bf16 v[40:55], v[26:29], v[26:29], 0
    v_mfma_f32_32x32x16_bf16 v[56:71], v[26:29], v[26:29], 0
    v_mfma_f32_32x32x16_bf16 v[72:87], v[26:29], v[26:29], 0
    v_mfma_f32_32x32x16_bf16 v[112:127], v[26:29], v[26:29], 0
    v_mfma_f32_32x32x16_bf16 v[208:223], v[26:29], v[26:29], 0
    v_lshl_add_u32 v29, v1, 4, s64
    v_mov_b32_e32 v27, 1
    s_lshr_b32 s67, s2, 5
    s_lshl_b32 s68, s67, 2
    v_and_b32_e32 v13, 3, v1
    v_add_u32_e32 v13, s68, v13
    v_mul_u32_u24_e32 v13, 9216, v13
    s_lshl_b32 s68, s67, 8
    v_and_b32_e32 v14, 1, v1
    v_lshl_add_u32 v14, v14, 7, s68
    v_bfe_u32 v224, v1, 1, 2
    v_lshl_add_u32 v35, v224, 11, v14
    s_bitcmp1_b32 s66, 0
    s_cselect_b32 s100, -64, 64
    s_cselect_b32 s67, -192, 0
    s_add_u32 s97, s57, s67
    s_lshl_b32 s97, s97, 5
    s_add_u32 s96, s57, s100
    s_mul_i32 s100, s100, 3
    s_mov_b32 s59, 2
    s_waitcnt lgkmcnt(0)
    s_setprio 1
    s_barrier
    ds_read_b64_tr_b16 v[88:89], v10 offset:6144
    ds_read_b64_tr_b16 v[90:91], v10 offset:6656
    ds_read_b64_tr_b16 v[92:93], v10 offset:7168
    ds_read_b64_tr_b16 v[94:95], v10 offset:7680
    buffer_load_dwordx4 v8, s[28:31], s58 offen lds
    buffer_load_dwordx4 v8, s[28:31], s58 offen offset:1024 lds
    s_waitcnt vmcnt(2)
    ds_read_b64_tr_b16 v[112:113], v2 offset:0
    ds_read_b64_tr_b16 v[114:115], v2 offset:1024
    ds_read_b64_tr_b16 v[116:117], v2 offset:2048
    ds_read_b64_tr_b16 v[118:119], v2 offset:3072
    ds_read_b64_tr_b16 v[104:105], v10 offset:22528
    ds_read_b64_tr_b16 v[106:107], v10 offset:23040
    ds_read_b64_tr_b16 v[108:109], v10 offset:23552
    ds_read_b64_tr_b16 v[110:111], v10 offset:24064
    ds_read_b64_tr_b16 v[96:97], v10 offset:14336
    ds_read_b64_tr_b16 v[98:99], v10 offset:14848
    ds_read_b64_tr_b16 v[100:101], v10 offset:15360
    ds_read_b64_tr_b16 v[102:103], v10 offset:15872
    v_mfma_f32_32x32x16_bf16 v[128:143], v[22:25], v[20:23], 0
    s_waitcnt lgkmcnt(8)
    v_mfma_f32_32x32x16_bf16 v[144:159], v[112:115], v[88:91], v[128:143]
    v_mfma_f32_32x32x16_bf16 v[144:159], v[116:119], v[92:95], v[144:159]
    buffer_load_ushort v22, v9, s[32:35], s57 offen
    s_nop 3
    buffer_load_dword v36, v13, s[24:27], s96 offen
    buffer_load_dword v37, v35, s[28:31], s97 offen
    s_nop 5
    s_waitcnt lgkmcnt(0)
    v_lshlrev_b32_sdwa v144, 1, v144 dst_sel:DWORD dst_unused:UNUSED_PAD src0_sel:DWORD src1_sel:WORD_1
    v_lshlrev_b32_sdwa v145, 1, v145 dst_sel:DWORD dst_unused:UNUSED_PAD src0_sel:DWORD src1_sel:WORD_1
    v_lshlrev_b32_sdwa v146, 1, v146 dst_sel:DWORD dst_unused:UNUSED_PAD src0_sel:DWORD src1_sel:WORD_1
    v_lshlrev_b32_sdwa v147, 1, v147 dst_sel:DWORD dst_unused:UNUSED_PAD src0_sel:DWORD src1_sel:WORD_1
    v_lshlrev_b32_sdwa v148, 1, v148 dst_sel:DWORD dst_unused:UNUSED_PAD src0_sel:DWORD src1_sel:WORD_1
    v_lshlrev_b32_sdwa v149, 1, v149 dst_sel:DWORD dst_unused:UNUSED_PAD src0_sel:DWORD src1_sel:WORD_1
    v_lshlrev_b32_sdwa v150, 1, v150 dst_sel:DWORD dst_unused:UNUSED_PAD src0_sel:DWORD src1_sel:WORD_1
    v_lshlrev_b32_sdwa v151, 1, v151 dst_sel:DWORD dst_unused:UNUSED_PAD src0_sel:DWORD src1_sel:WORD_1
    s_mov_b32 s60, 11
.p2align 6
L_loop1:
    ds_read_u16_d16_hi v192, v144 offset:65280
    ds_read_u16_d16_hi v193, v145 offset:65280
    ds_read_u16_d16_hi v194, v146 offset:65280
    ds_read_u16_d16_hi v195, v147 offset:65280
    ds_read_u16_d16_hi v196, v148 offset:65280
    ds_read_u16_d16_hi v197, v149 offset:65280
    ds_read_u16_d16_hi v198, v150 offset:65280
    ds_read_u16_d16_hi v199, v151 offset:65280
    s_waitcnt lgkmcnt(8)
    s_nop 0
    v_mfma_f32_32x32x16_bf16 v[176:191], v[112:115], v[104:107], v[128:143]
    v_lshlrev_b32_sdwa v152, 1, v152 dst_sel:DWORD dst_unused:UNUSED_PAD src0_sel:DWORD src1_sel:WORD_1
    v_lshlrev_b32_sdwa v153, 1, v153 dst_sel:DWORD dst_unused:UNUSED_PAD src0_sel:DWORD src1_sel:WORD_1
    v_lshlrev_b32_sdwa v154, 1, v154 dst_sel:DWORD dst_unused:UNUSED_PAD src0_sel:DWORD src1_sel:WORD_1
    v_lshlrev_b32_sdwa v155, 1, v155 dst_sel:DWORD dst_unused:UNUSED_PAD src0_sel:DWORD src1_sel:WORD_1
    v_mfma_f32_32x32x16_bf16 v[176:191], v[116:119], v[108:111], v[176:191]
    v_lshlrev_b32_sdwa v156, 1, v156 dst_sel:DWORD dst_unused:UNUSED_PAD src0_sel:DWORD src1_sel:WORD_1
    v_lshlrev_b32_sdwa v157, 1, v157 dst_sel:DWORD dst_unused:UNUSED_PAD src0_sel:DWORD src1_sel:WORD_1
    v_lshlrev_b32_sdwa v158, 1, v158 dst_sel:DWORD dst_unused:UNUSED_PAD src0_sel:DWORD src1_sel:WORD_1
    v_lshlrev_b32_sdwa v159, 1, v159 dst_sel:DWORD dst_unused:UNUSED_PAD src0_sel:DWORD src1_sel:WORD_1
    v_smfmac_f32_32x32x32_bf16 v[56:71], v[120:123], v[208:215], v12
    ds_read_u16_d16_hi v200, v152 offset:65280
    ds_read_u16_d16_hi v201, v153 offset:65280
    ds_read_u16_d16_hi v202, v154 offset:65280
    ds_read_u16_d16_hi v203, v155 offset:65280
    s_nop 1
    s_nop 0
    v_smfmac_f32_32x32x32_bf16 v[56:71], v[124:127], v[216:223], v12
    v_lshlrev_b32_sdwa v176, 1, v176 dst_sel:DWORD dst_unused:UNUSED_PAD src0_sel:DWORD src1_sel:WORD_1
    v_lshlrev_b32_sdwa v177, 1, v177 dst_sel:DWORD dst_unused:UNUSED_PAD src0_sel:DWORD src1_sel:WORD_1
    v_lshlrev_b32_sdwa v178, 1, v178 dst_sel:DWORD dst_unused:UNUSED_PAD src0_sel:DWORD src1_sel:WORD_1
    v_lshlrev_b32_sdwa v179, 1, v179 dst_sel:DWORD dst_unused:UNUSED_PAD src0_sel:DWORD src1_sel:WORD_1
    v_lshlrev_b32_sdwa v180, 1, v180 dst_sel:DWORD dst_unused:UNUSED_PAD src0_sel:DWORD src1_sel:WORD_1
    v_lshlrev_b32_sdwa v181, 1, v181 dst_sel:DWORD dst_unused:UNUSED_PAD src0_sel:DWORD src1_sel:WORD_1
    v_lshlrev_b32_sdwa v182, 1, v182 dst_sel:DWORD dst_unused:UNUSED_PAD src0_sel:DWORD src1_sel:WORD_1
    v_lshlrev_b32_sdwa v183, 1, v183 dst_sel:DWORD dst_unused:UNUSED_PAD src0_sel:DWORD src1_sel:WORD_1
    s_waitcnt vmcnt(2)
    ds_read_b64_tr_b16 v[120:121], v3 offset:0
    ds_read_b64_tr_b16 v[122:123], v3 offset:256
    ds_read_b64_tr_b16 v[124:125], v3 offset:1024
    ds_read_b64_tr_b16 v[126:127], v3 offset:1280
    ds_read_u16_d16_hi v204, v156 offset:65280
    ds_read_u16_d16_hi v205, v157 offset:65280
    ds_read_u16_d16_hi v206, v158 offset:65280
    ds_read_u16_d16_hi v207, v159 offset:65280
    ds_read_u16_d16_hi v224, v176 offset:65280
    ds_read_u16_d16_hi v225, v177 offset:65280
    ds_read_u16_d16_hi v226, v178 offset:65280
    ds_read_u16_d16_hi v227, v179 offset:65280
    ds_read_u16_d16_hi v228, v180 offset:65280
    ds_read_u16_d16_hi v229, v181 offset:65280
    ds_read_u16_d16_hi v230, v182 offset:65280
    ds_read_u16_d16_hi v231, v183 offset:65280
    s_waitcnt lgkmcnt(8)
    s_lshl_b32 s58, s57, 101
    v_mfma_f32_32x32x16_bf16 v[160:175], v[112:115], v[96:99], v[128:143]
    v_lshlrev_b32_sdwa v184, 1, v184 dst_sel:DWORD dst_unused:UNUSED_PAD src0_sel:DWORD src1_sel:WORD_1
    v_lshlrev_b32_sdwa v185, 1, v185 dst_sel:DWORD dst_unused:UNUSED_PAD src0_sel:DWORD src1_sel:WORD_1
    v_lshlrev_b32_sdwa v186, 1, v186 dst_sel:DWORD dst_unused:UNUSED_PAD src0_sel:DWORD src1_sel:WORD_1
    v_lshlrev_b32_sdwa v187, 1, v187 dst_sel:DWORD dst_unused:UNUSED_PAD src0_sel:DWORD src1_sel:WORD_1
    v_mfma_f32_32x32x16_bf16 v[160:175], v[116:119], v[100:103], v[160:175]
    v_lshlrev_b32_sdwa v188, 1, v188 dst_sel:DWORD dst_unused:UNUSED_PAD src0_sel:DWORD src1_sel:WORD_1
    v_lshlrev_b32_sdwa v189, 1, v189 dst_sel:DWORD dst_unused:UNUSED_PAD src0_sel:DWORD src1_sel:WORD_1
    v_lshlrev_b32_sdwa v190, 1, v190 dst_sel:DWORD dst_unused:UNUSED_PAD src0_sel:DWORD src1_sel:WORD_1
    v_lshlrev_b32_sdwa v191, 1, v191 dst_sel:DWORD dst_unused:UNUSED_PAD src0_sel:DWORD src1_sel:WORD_1
    v_smfmac_f32_32x32x32_bf16 v[40:55], v[120:123], v[192:199], v12
    ds_read_u16_d16_hi v232, v184 offset:65280
    ds_read_u16_d16_hi v233, v185 offset:65280
    ds_read_u16_d16_hi v234, v186 offset:65280
    ds_read_u16_d16_hi v235, v187 offset:65280
    v_xor_b32_e64 v2, 64, v2
    v_readlane_b32 s57, v11, s59
    v_smfmac_f32_32x32x32_bf16 v[40:55], v[124:127], v[200:207], v12
    v_lshlrev_b32_sdwa v160, 1, v160 dst_sel:DWORD dst_unused:UNUSED_PAD src0_sel:DWORD src1_sel:WORD_1
    v_lshlrev_b32_sdwa v161, 1, v161 dst_sel:DWORD dst_unused:UNUSED_PAD src0_sel:DWORD src1_sel:WORD_1
    v_lshlrev_b32_sdwa v162, 1, v162 dst_sel:DWORD dst_unused:UNUSED_PAD src0_sel:DWORD src1_sel:WORD_1
    v_lshlrev_b32_sdwa v163, 1, v163 dst_sel:DWORD dst_unused:UNUSED_PAD src0_sel:DWORD src1_sel:WORD_1
    v_lshlrev_b32_sdwa v164, 1, v164 dst_sel:DWORD dst_unused:UNUSED_PAD src0_sel:DWORD src1_sel:WORD_1
    v_lshlrev_b32_sdwa v165, 1, v165 dst_sel:DWORD dst_unused:UNUSED_PAD src0_sel:DWORD src1_sel:WORD_1
    v_mfma_f32_32x32x16_bf16 v[128:143], v[22:25], v[20:23], 0
    v_lshlrev_b32_sdwa v166, 1, v166 dst_sel:DWORD dst_unused:UNUSED_PAD src0_sel:DWORD src1_sel:WORD_1
    v_lshlrev_b32_sdwa v167, 1, v167 dst_sel:DWORD dst_unused:UNUSED_PAD src0_sel:DWORD src1_sel:WORD_1
    ds_read_b64_tr_b16 v[112:113], v2 offset:0
    ds_read_b64_tr_b16 v[114:115], v2 offset:1024
    ds_read_b64_tr_b16 v[116:117], v2 offset:2048
    ds_read_b64_tr_b16 v[118:119], v2 offset:3072
    ds_read_u16_d16_hi v236, v188 offset:65280
    ds_read_u16_d16_hi v237, v189 offset:65280
    ds_read_u16_d16_hi v238, v190 offset:65280
    ds_read_u16_d16_hi v239, v191 offset:65280
    s_waitcnt lgkmcnt(4)
    s_mov_b32 m0, s65
    s_and_b32 s61, s57, 0xffffff80
    buffer_load_dwordx4 v8, s[28:31], s58 offen lds
    buffer_load_dwordx4 v8, s[28:31], s58 offen offset:1024 lds
    s_mov_b32 m0, s64
    s_bitcmp1_b32 s59, 0
    buffer_load_ushort v22, v9, s[32:35], s57 offen
    s_cbranch_scc1 L_np1
    buffer_load_dwordx4 v4, s[24:27], s61 offen offset:0 lds
    buffer_load_dwordx4 v5, s[24:27], s61 offen offset:1024 lds
    buffer_load_dwordx4 v6, s[24:27], s61 offen offset:2048 lds
    buffer_load_dwordx4 v7, s[24:27], s61 offen offset:3072 lds
L_np1:
    s_add_u32 s59, s59, 1
    s_add_u32 s96, s57, s100
    s_lshl_b32 s97, s96, 5
    buffer_load_dword v36, v13, s[24:27], s96 offen
    buffer_load_dword v37, v14, s[28:31], s97 offen
    ds_read_u16_d16_hi v208, v160 offset:65280
    ds_read_u16_d16_hi v209, v161 offset:65280
    ds_read_u16_d16_hi v210, v162 offset:65280
    ds_read_u16_d16_hi v211, v163 offset:65280
    ds_read_u16_d16_hi v212, v164 offset:65280
    ds_read_u16_d16_hi v213, v165 offset:65280
    ds_read_u16_d16_hi v214, v166 offset:65280
    ds_read_u16_d16_hi v215, v167 offset:65280
    s_waitcnt lgkmcnt(8)
    s_nop 0
    v_mfma_f32_32x32x16_bf16 v[144:159], v[112:115], v[88:91], v[128:143]
    v_lshlrev_b32_sdwa v168, 1, v168 dst_sel:DWORD dst_unused:UNUSED_PAD src0_sel:DWORD src1_sel:WORD_1
    v_lshlrev_b32_sdwa v169, 1, v169 dst_sel:DWORD dst_unused:UNUSED_PAD src0_sel:DWORD src1_sel:WORD_1
    v_lshlrev_b32_sdwa v170, 1, v170 dst_sel:DWORD dst_unused:UNUSED_PAD src0_sel:DWORD src1_sel:WORD_1
    v_lshlrev_b32_sdwa v171, 1, v171 dst_sel:DWORD dst_unused:UNUSED_PAD src0_sel:DWORD src1_sel:WORD_1
    v_mfma_f32_32x32x16_bf16 v[144:159], v[116:119], v[92:95], v[144:159]
    v_lshlrev_b32_sdwa v172, 1, v172 dst_sel:DWORD dst_unused:UNUSED_PAD src0_sel:DWORD src1_sel:WORD_1
    v_lshlrev_b32_sdwa v173, 1, v173 dst_sel:DWORD dst_unused:UNUSED_PAD src0_sel:DWORD src1_sel:WORD_1
    v_lshlrev_b32_sdwa v174, 1, v174 dst_sel:DWORD dst_unused:UNUSED_PAD src0_sel:DWORD src1_sel:WORD_1
    v_lshlrev_b32_sdwa v175, 1, v175 dst_sel:DWORD dst_unused:UNUSED_PAD src0_sel:DWORD src1_sel:WORD_1
    v_smfmac_f32_32x32x32_bf16 v[72:87], v[120:123], v[224:231], v12
    ds_read_u16_d16_hi v216, v168 offset:65280
    ds_read_u16_d16_hi v217, v169 offset:65280
    ds_read_u16_d16_hi v218, v170 offset:65280
    ds_read_u16_d16_hi v219, v171 offset:65280
    s_nop 1
    s_nop 0
    v_smfmac_f32_32x32x32_bf16 v[72:87], v[124:127], v[232:239], v12
    v_lshlrev_b32_sdwa v144, 1, v144 dst_sel:DWORD dst_unused:UNUSED_PAD src0_sel:DWORD src1_sel:WORD_1
    v_lshlrev_b32_sdwa v145, 1, v145 dst_sel:DWORD dst_unused:UNUSED_PAD src0_sel:DWORD src1_sel:WORD_1
    v_lshlrev_b32_sdwa v146, 1, v146 dst_sel:DWORD dst_unused:UNUSED_PAD src0_sel:DWORD src1_sel:WORD_1
    v_lshlrev_b32_sdwa v147, 1, v147 dst_sel:DWORD dst_unused:UNUSED_PAD src0_sel:DWORD src1_sel:WORD_1
    v_lshlrev_b32_sdwa v148, 1, v148 dst_sel:DWORD dst_unused:UNUSED_PAD src0_sel:DWORD src1_sel:WORD_1
    v_lshlrev_b32_sdwa v149, 1, v149 dst_sel:DWORD dst_unused:UNUSED_PAD src0_sel:DWORD src1_sel:WORD_1
    v_lshlrev_b32_sdwa v150, 1, v150 dst_sel:DWORD dst_unused:UNUSED_PAD src0_sel:DWORD src1_sel:WORD_1
    v_lshlrev_b32_sdwa v151, 1, v151 dst_sel:DWORD dst_unused:UNUSED_PAD src0_sel:DWORD src1_sel:WORD_1
    ds_read_u16_d16_hi v220, v172 offset:65280
    ds_read_u16_d16_hi v221, v173 offset:65280
    ds_read_u16_d16_hi v222, v174 offset:65280
    ds_read_u16_d16_hi v223, v175 offset:65280
    s_cmp_lt_u32 s59, s60
    s_cbranch_scc1 L_loop1
    s_cmp_eq_u32 s63, 3
    ds_write_b128 v29, v[72:75] offset:6144
    ds_write_b128 v29, v[76:79] offset:7168
    ds_write_b128 v29, v[80:83] offset:38912
    s_cbranch_scc1 L_S0x
    ds_write_b128 v29, v[84:87] offset:39936
L_S0x:
    s_mov_b64 exec, 1
    ds_add_u32 v26, v27 offset:64512
    s_mov_b64 exec, -1
    s_mul_i32 s70, s63, 1
    s_add_u32 s70, s70, 12
    s_mov_b32 s3, 0
.p2align 6
L_loop2:
    ds_read_u16_d16_hi v192, v144 offset:65280
    ds_read_u16_d16_hi v193, v145 offset:65280
    ds_read_u16_d16_hi v194, v146 offset:65280
    ds_read_u16_d16_hi v195, v147 offset:65280
    ds_read_u16_d16_hi v196, v148 offset:65280
    ds_read_u16_d16_hi v197, v149 offset:65280
    ds_read_u16_d16_hi v198, v150 offset:65280
    ds_read_u16_d16_hi v199, v151 offset:65280
    s_waitcnt lgkmcnt(8)
    s_lshl_b32 s58, s57, 5
    v_mfma_f32_32x32x16_bf16 v[160:175], v[112:115], v[96:99], v[128:143]
    v_lshlrev_b32_sdwa v152, 1, v152 dst_sel:DWORD dst_unused:UNUSED_PAD src0_sel:DWORD src1_sel:WORD_1
    v_lshlrev_b32_sdwa v153, 1, v153 dst_sel:DWORD dst_unused:UNUSED_PAD src0_sel:DWORD src1_sel:WORD_1
    v_lshlrev_b32_sdwa v154, 1, v154 dst_sel:DWORD dst_unused:UNUSED_PAD src0_sel:DWORD src1_sel:WORD_1
    v_lshlrev_b32_sdwa v155, 1, v155 dst_sel:DWORD dst_unused:UNUSED_PAD src0_sel:DWORD src1_sel:WORD_1
    v_mfma_f32_32x32x16_bf16 v[160:175], v[116:119], v[100:103], v[160:175]
    v_lshlrev_b32_sdwa v156, 1, v156 dst_sel:DWORD dst_unused:UNUSED_PAD src0_sel:DWORD src1_sel:WORD_1
    v_lshlrev_b32_sdwa v157, 1, v157 dst_sel:DWORD dst_unused:UNUSED_PAD src0_sel:DWORD src1_sel:WORD_1
    v_lshlrev_b32_sdwa v158, 1, v158 dst_sel:DWORD dst_unused:UNUSED_PAD src0_sel:DWORD src1_sel:WORD_1
    v_lshlrev_b32_sdwa v159, 1, v159 dst_sel:DWORD dst_unused:UNUSED_PAD src0_sel:DWORD src1_sel:WORD_1
    v_smfmac_f32_32x32x32_bf16 v[56:71], v[120:123], v[208:215], v12
    ds_read_u16_d16_hi v200, v152 offset:65280
    ds_read_u16_d16_hi v201, v153 offset:65280
    ds_read_u16_d16_hi v202, v154 offset:65280
    ds_read_u16_d16_hi v203, v155 offset:65280
    v_xor_b32_e64 v2, 64, v2
    v_readlane_b32 s57, v11, s59
    v_smfmac_f32_32x32x32_bf16 v[56:71], v[124:127], v[216:223], v12
    v_lshlrev_b32_sdwa v160, 1, v160 dst_sel:DWORD dst_unused:UNUSED_PAD src0_sel:DWORD src1_sel:WORD_1
    v_lshlrev_b32_sdwa v161, 1, v161 dst_sel:DWORD dst_unused:UNUSED_PAD src0_sel:DWORD src1_sel:WORD_1
    v_lshlrev_b32_sdwa v162, 1, v162 dst_sel:DWORD dst_unused:UNUSED_PAD src0_sel:DWORD src1_sel:WORD_1
    v_lshlrev_b32_sdwa v163, 1, v163 dst_sel:DWORD dst_unused:UNUSED_PAD src0_sel:DWORD src1_sel:WORD_1
    v_lshlrev_b32_sdwa v164, 1, v164 dst_sel:DWORD dst_unused:UNUSED_PAD src0_sel:DWORD src1_sel:WORD_1
    v_lshlrev_b32_sdwa v165, 1, v165 dst_sel:DWORD dst_unused:UNUSED_PAD src0_sel:DWORD src1_sel:WORD_1
    s_waitcnt vmcnt(0)
    v_mfma_f32_32x32x16_bf16 v[128:143], v[22:25], v[20:23], 0
    v_lshlrev_b32_sdwa v166, 1, v166 dst_sel:DWORD dst_unused:UNUSED_PAD src0_sel:DWORD src1_sel:WORD_1
    v_lshlrev_b32_sdwa v167, 1, v167 dst_sel:DWORD dst_unused:UNUSED_PAD src0_sel:DWORD src1_sel:WORD_1
    ds_read_b64_tr_b16 v[120:121], v3 offset:0
    ds_read_b64_tr_b16 v[122:123], v3 offset:256
    ds_read_b64_tr_b16 v[124:125], v3 offset:1024
    ds_read_b64_tr_b16 v[126:127], v3 offset:1280
    ds_read_b64_tr_b16 v[112:113], v2 offset:0
    ds_read_b64_tr_b16 v[114:115], v2 offset:1024
    ds_read_b64_tr_b16 v[116:117], v2 offset:2048
    ds_read_b64_tr_b16 v[118:119], v2 offset:3072
    ds_read_u16_d16_hi v204, v156 offset:65280
    ds_read_u16_d16_hi v205, v157 offset:65280
    ds_read_u16_d16_hi v206, v158 offset:65280
    ds_read_u16_d16_hi v207, v159 offset:65280
    s_cmp_eq_u32 s59, s70
    s_cbranch_scc1 L_event
L_back:
    s_waitcnt lgkmcnt(4)
    s_mov_b32 m0, s65
    s_and_b32 s61, s57, 0xffffff80
    buffer_load_dwordx4 v8, s[28:31], s58 offen lds
    buffer_load_dwordx4 v8, s[28:31], s58 offen offset:1024 lds
    s_mov_b32 m0, s64
    s_bitcmp1_b32 s59, 0
    buffer_load_ushort v22, v9, s[32:35], s57 offen
    s_cbranch_scc1 L_np2
    buffer_load_dwordx4 v4, s[24:27], s61 offen offset:0 lds
    buffer_load_dwordx4 v5, s[24:27], s61 offen offset:1024 lds
    buffer_load_dwordx4 v6, s[24:27], s61 offen offset:2048 lds
    buffer_load_dwordx4 v7, s[24:27], s61 offen offset:3072 lds
L_np2:
    s_add_u32 s59, s59, 1
    ds_read_u16_d16_hi v208, v160 offset:65280
    ds_read_u16_d16_hi v209, v161 offset:65280
    ds_read_u16_d16_hi v210, v162 offset:65280
    ds_read_u16_d16_hi v211, v163 offset:65280
    ds_read_u16_d16_hi v212, v164 offset:65280
    ds_read_u16_d16_hi v213, v165 offset:65280
    ds_read_u16_d16_hi v214, v166 offset:65280
    ds_read_u16_d16_hi v215, v167 offset:65280
    s_waitcnt lgkmcnt(8)
    v_mfma_f32_32x32x16_bf16 v[144:159], v[112:115], v[88:91], v[128:143]
    v_lshlrev_b32_sdwa v168, 1, v168 dst_sel:DWORD dst_unused:UNUSED_PAD src0_sel:DWORD src1_sel:WORD_1
    v_lshlrev_b32_sdwa v169, 1, v169 dst_sel:DWORD dst_unused:UNUSED_PAD src0_sel:DWORD src1_sel:WORD_1
    v_lshlrev_b32_sdwa v170, 1, v170 dst_sel:DWORD dst_unused:UNUSED_PAD src0_sel:DWORD src1_sel:WORD_1
    v_lshlrev_b32_sdwa v171, 1, v171 dst_sel:DWORD dst_unused:UNUSED_PAD src0_sel:DWORD src1_sel:WORD_1
    v_mfma_f32_32x32x16_bf16 v[144:159], v[116:119], v[92:95], v[144:159]
    v_lshlrev_b32_sdwa v172, 1, v172 dst_sel:DWORD dst_unused:UNUSED_PAD src0_sel:DWORD src1_sel:WORD_1
    v_lshlrev_b32_sdwa v173, 1, v173 dst_sel:DWORD dst_unused:UNUSED_PAD src0_sel:DWORD src1_sel:WORD_1
    v_lshlrev_b32_sdwa v174, 1, v174 dst_sel:DWORD dst_unused:UNUSED_PAD src0_sel:DWORD src1_sel:WORD_1
    v_lshlrev_b32_sdwa v175, 1, v175 dst_sel:DWORD dst_unused:UNUSED_PAD src0_sel:DWORD src1_sel:WORD_1
    v_smfmac_f32_32x32x32_bf16 v[40:55], v[120:123], v[192:199], v12
    ds_read_u16_d16_hi v216, v168 offset:65280
    ds_read_u16_d16_hi v217, v169 offset:65280
    ds_read_u16_d16_hi v218, v170 offset:65280
    ds_read_u16_d16_hi v219, v171 offset:65280
    s_nop 1
    s_nop 0
    v_smfmac_f32_32x32x32_bf16 v[40:55], v[124:127], v[200:207], v12
    v_lshlrev_b32_sdwa v144, 1, v144 dst_sel:DWORD dst_unused:UNUSED_PAD src0_sel:DWORD src1_sel:WORD_1
    v_lshlrev_b32_sdwa v145, 1, v145 dst_sel:DWORD dst_unused:UNUSED_PAD src0_sel:DWORD src1_sel:WORD_1
    v_lshlrev_b32_sdwa v146, 1, v146 dst_sel:DWORD dst_unused:UNUSED_PAD src0_sel:DWORD src1_sel:WORD_1
    v_lshlrev_b32_sdwa v147, 1, v147 dst_sel:DWORD dst_unused:UNUSED_PAD src0_sel:DWORD src1_sel:WORD_1
    v_lshlrev_b32_sdwa v148, 1, v148 dst_sel:DWORD dst_unused:UNUSED_PAD src0_sel:DWORD src1_sel:WORD_1
    v_lshlrev_b32_sdwa v149, 1, v149 dst_sel:DWORD dst_unused:UNUSED_PAD src0_sel:DWORD src1_sel:WORD_1
    v_lshlrev_b32_sdwa v150, 1, v150 dst_sel:DWORD dst_unused:UNUSED_PAD src0_sel:DWORD src1_sel:WORD_1
    v_lshlrev_b32_sdwa v151, 1, v151 dst_sel:DWORD dst_unused:UNUSED_PAD src0_sel:DWORD src1_sel:WORD_1
    ds_read_u16_d16_hi v220, v172 offset:65280
    ds_read_u16_d16_hi v221, v173 offset:65280
    ds_read_u16_d16_hi v222, v174 offset:65280
    ds_read_u16_d16_hi v223, v175 offset:65280
    s_branch L_loop2
L_event:
    s_add_u32 s70, s70, 1
    s_cmp_eq_u32 s3, 1
    s_cbranch_scc1 L_S2
    s_cmp_eq_u32 s3, 3
    s_cbranch_scc1 L_drainL
    s_cmp_eq_u32 s3, 2
    s_cbranch_scc1 L_S3
    s_mov_b32 s44, s16
    s_and_b32 s45, s17, 0xffff
    s_mov_b32 s46, 256
    s_mov_b32 s47, 0x20000
    s_mov_b32 s20, s18
    s_and_b32 s21, s19, 0xffff
    s_mov_b32 s22, 1048576
    s_mov_b32 s23, 0x20000
    s_mov_b32 s40, s14
    s_and_b32 s41, s15, 0xffff
    s_mov_b32 s42, 1179648
    s_mov_b32 s43, 0x20000
    s_mov_b32 s36, s12
    s_and_b32 s37, s13, 0xffff
    s_mov_b32 s38, 64
    s_mov_b32 s39, 0x20000
    s_lshl_b32 s99, s54, 10
    v_lshl_add_u32 v15, v1, 4, s99
    v_xor_b32_e32 v16, 4096, v15
    v_bfe_u32 v33, v1, 3, 1
    v_lshrrev_b32_e32 v32, 4, v1
    v_lshl_add_u32 v32, v33, 2, v32
    v_and_b32_e32 v33, 7, v1
    v_mul_u32_u24_e32 v18, 1152, v32
    v_lshl_add_u32 v18, v33, 3, v18
    v_lshlrev_b32_e32 v32, 1, v32
    v_lshlrev_b32_e32 v17, 2, v1
    v_mov_b32_e32 v30, 0
    s_mul_i32 s99, s55, 36864
    s_mul_i32 s101, s63, 9216
    s_add_u32 s99, s99, s101
    s_lshr_b32 s101, s56, 2
    s_lshl_b32 s101, s101, 6
    s_add_u32 s101, s101, s99
    s_add_u32 s101, s101, 1024
    s_lshl_b32 s67, s56, 7
    s_add_u32 s99, s99, s67
    s_lshr_b32 s67, s54, 2
    s_lshl_b32 s67, s67, 6
    s_add_u32 s99, s99, s67
    s_lshl_b32 s67, s63, 4
    buffer_load_short_d16_hi v30, v32, s[36:39], s67 offen
    s_lshr_b32 s67, s56, 2
    s_lshl_b32 s68, s55, 1
    s_add_u32 s67, s67, s68
    s_lshl_b32 s71, s67, 2
    s_add_u32 s67, s71, s63
    s_lshl_b32 s52, s67, 12
    s_lshl_b32 s68, s66, 10
    s_add_u32 s53, s68, s52
    s_lshl_b32 s67, s63, 10
    s_add_u32 s68, s67, 6144
    s_add_u32 s67, s67, 36864
    s_cmp_lt_u32 s63, 2
    s_cselect_b32 s67, s68, s67
    v_lshl_add_u32 v28, v1, 4, s67
    s_lshr_b32 s98, s2, 3
    s_mul_i32 s98, s98, 3
    s_lshr_b32 s98, s98, 5
L_S1:
    ds_read_b32 v33, v26 offset:64512
    s_cmp_eq_u32 s63, 3
    ds_read_b128 v[72:75], v28 offset:0
    ds_read_b128 v[76:79], v28 offset:8192
    ds_read_b128 v[80:83], v28 offset:16384
    s_cbranch_scc1 L_S1x
    ds_read_b128 v[84:87], v28 offset:24576
L_S1x:
    s_waitcnt lgkmcnt(0)
    v_readfirstlane_b32 s67, v33
    s_mov_b32 s3, 1
    s_cmp_lt_u32 s67, 4
    s_cbranch_scc1 L_S1
    v_pk_add_f32 v[72:73], v[72:73], v[76:77]
    v_pk_add_f32 v[74:75], v[74:75], v[78:79]
    v_pk_add_f32 v[80:81], v[80:81], v[84:85]
    v_pk_add_f32 v[82:83], v[82:83], v[86:87]
    v_pk_add_f32 v[72:73], v[72:73], v[80:81]
    v_pk_add_f32 v[74:75], v[74:75], v[82:83]
    buffer_store_dword v72, v17, s[20:23], s53 offen offset:0 sc1
    buffer_store_dword v73, v17, s[20:23], s53 offen offset:256 sc1
    buffer_store_dword v74, v17, s[20:23], s53 offen offset:512 sc1
    buffer_store_dword v75, v17, s[20:23], s53 offen offset:768 sc1
    s_add_u32 s70, s70, s98
    s_branch L_back
L_S2:
    s_mov_b64 exec, 1
    ds_add_rtn_u32 v33, v26, v27 offset:64520
    s_waitcnt lgkmcnt(0)
    v_readfirstlane_b32 s67, v33
    v_mov_b32_e32 v33, 1
    s_cmp_eq_u32 s67, 3
    s_cselect_b32 s70, s70, 21
    s_cselect_b32 s3, 2, 3
    s_cbranch_scc0 L_S2x
    buffer_atomic_add v33, v26, s[44:47], s71 offen sc0 sc1
L_S2x:
    s_mov_b64 exec, -1
    s_branch L_back
L_S3:
    s_mov_b32 s70, 21
    s_mov_b32 s3, 3
    s_mov_b64 exec, 1
    v_add_u32_e32 v33, 1, v33
    ds_write_b32 v26, v33 offset:64524
    s_mov_b64 exec, -1
    s_branch L_back
L_proV2:
    s_waitcnt vmcnt(8)
    v_dot2c_f32_bf16_e32 v72, v144, v226
    v_dot2c_f32_bf16_e32 v73, v145, v226
    v_dot2c_f32_bf16_e32 v74, v146, v226
    v_dot2c_f32_bf16_e32 v75, v147, v226
    v_dot2c_f32_bf16_e32 v76, v144, v144
    v_dot2c_f32_bf16_e32 v77, v145, v145
    v_dot2c_f32_bf16_e32 v78, v146, v146
    v_dot2c_f32_bf16_e32 v79, v147, v147
    v_lshlrev_b32_e32 v192, 16, v144
    v_and_b32_e32 v193, 0xffff0000, v144
    v_lshlrev_b32_e32 v194, 16, v145
    v_and_b32_e32 v195, 0xffff0000, v145
    v_lshlrev_b32_e32 v196, 16, v146
    v_and_b32_e32 v197, 0xffff0000, v146
    v_lshlrev_b32_e32 v198, 16, v147
    v_and_b32_e32 v199, 0xffff0000, v147
    v_lshlrev_b32_e32 v200, 16, v180
    v_and_b32_e32 v201, 0xffff0000, v180
    v_lshlrev_b32_e32 v202, 16, v181
    v_and_b32_e32 v203, 0xffff0000, v181
    s_waitcnt vmcnt(7)
    v_dot2c_f32_bf16_e32 v72, v148, v226
    v_dot2c_f32_bf16_e32 v73, v149, v226
    v_dot2c_f32_bf16_e32 v74, v150, v226
    v_dot2c_f32_bf16_e32 v75, v151, v226
    v_dot2c_f32_bf16_e32 v76, v148, v148
    v_dot2c_f32_bf16_e32 v77, v149, v149
    v_dot2c_f32_bf16_e32 v78, v150, v150
    v_dot2c_f32_bf16_e32 v79, v151, v151
    s_waitcnt vmcnt(6)
    v_dot2c_f32_bf16_e32 v72, v152, v226
    v_dot2c_f32_bf16_e32 v73, v153, v226
    v_dot2c_f32_bf16_e32 v74, v154, v226
    v_dot2c_f32_bf16_e32 v75, v155, v226
    v_dot2c_f32_bf16_e32 v76, v152, v152
    v_dot2c_f32_bf16_e32 v77, v153, v153
    v_dot2c_f32_bf16_e32 v78, v154, v154
    v_dot2c_f32_bf16_e32 v79, v155, v155
    s_waitcnt vmcnt(5)
    v_dot2c_f32_bf16_e32 v72, v156, v226
    v_dot2c_f32_bf16_e32 v73, v157, v226
    v_dot2c_f32_bf16_e32 v74, v158, v226
    v_dot2c_f32_bf16_e32 v75, v159, v226
    v_dot2c_f32_bf16_e32 v76, v156, v156
    v_dot2c_f32_bf16_e32 v77, v157, v157
    v_dot2c_f32_bf16_e32 v78, v158, v158
    v_dot2c_f32_bf16_e32 v79, v159, v159
    s_waitcnt vmcnt(4)
    v_dot2c_f32_bf16_e32 v72, v160, v226
    v_dot2c_f32_bf16_e32 v73, v161, v226
    v_dot2c_f32_bf16_e32 v74, v162, v226
    v_dot2c_f32_bf16_e32 v75, v163, v226
    v_dot2c_f32_bf16_e32 v76, v160, v160
    v_dot2c_f32_bf16_e32 v77, v161, v161
    v_dot2c_f32_bf16_e32 v78, v162, v162
    v_dot2c_f32_bf16_e32 v79, v163, v163
    buffer_load_dwordx4 v4, s[24:27], s61 offen offset:0 lds
    buffer_load_dwordx4 v5, s[24:27], s61 offen offset:1024 lds
    buffer_load_dwordx4 v6, s[24:27], s61 offen offset:2048 lds
    buffer_load_dwordx4 v7, s[24:27], s61 offen offset:3072 lds
    buffer_load_ushort v22, v9, s[32:35], s57 offen
    s_waitcnt vmcnt(8)
    v_dot2c_f32_bf16_e32 v72, v164, v226
    v_dot2c_f32_bf16_e32 v73, v165, v226
    v_dot2c_f32_bf16_e32 v74, v166, v226
    v_dot2c_f32_bf16_e32 v75, v167, v226
    v_dot2c_f32_bf16_e32 v76, v164, v164
    v_dot2c_f32_bf16_e32 v77, v165, v165
    v_dot2c_f32_bf16_e32 v78, v166, v166
    v_dot2c_f32_bf16_e32 v79, v167, v167
    s_waitcnt vmcnt(7)
    v_dot2c_f32_bf16_e32 v72, v168, v226
    v_dot2c_f32_bf16_e32 v73, v169, v226
    v_dot2c_f32_bf16_e32 v74, v170, v226
    v_dot2c_f32_bf16_e32 v75, v171, v226
    v_dot2c_f32_bf16_e32 v76, v168, v168
    v_dot2c_f32_bf16_e32 v77, v169, v169
    v_dot2c_f32_bf16_e32 v78, v170, v170
    v_dot2c_f32_bf16_e32 v79, v171, v171
    s_waitcnt vmcnt(6)
    v_dot2c_f32_bf16_e32 v72, v172, v226
    v_dot2c_f32_bf16_e32 v73, v173, v226
    v_dot2c_f32_bf16_e32 v74, v174, v226
    v_dot2c_f32_bf16_e32 v75, v175, v226
    v_dot2c_f32_bf16_e32 v76, v172, v172
    v_dot2c_f32_bf16_e32 v77, v173, v173
    v_dot2c_f32_bf16_e32 v78, v174, v174
    v_dot2c_f32_bf16_e32 v79, v175, v175
    s_waitcnt vmcnt(5)
    v_dot2c_f32_bf16_e32 v72, v176, v226
    v_dot2c_f32_bf16_e32 v73, v177, v226
    v_dot2c_f32_bf16_e32 v74, v178, v226
    v_dot2c_f32_bf16_e32 v75, v179, v226
    v_dot2c_f32_bf16_e32 v76, v176, v176
    v_dot2c_f32_bf16_e32 v77, v177, v177
    v_dot2c_f32_bf16_e32 v78, v178, v178
    v_dot2c_f32_bf16_e32 v79, v179, v179
    v_pk_add_f32 v[72:73], v[72:73], v[74:75]
    s_mov_b32 m0, s65
    s_nop 1
    v_pk_add_f32 v[76:77], v[76:77], v[78:79]
    v_add_f32_e32 v72, v72, v73
    v_add_f32_e32 v76, v76, v77
    s_nop 0
    v_add_f32_dpp v72, v72, v72 quad_perm:[1,0,3,2] row_mask:0xf bank_mask:0xf
    v_add_f32_dpp v76, v76, v76 quad_perm:[1,0,3,2] row_mask:0xf bank_mask:0xf
    s_nop 0
    v_add_f32_dpp v72, v72, v72 quad_perm:[2,3,0,1] row_mask:0xf bank_mask:0xf
    v_add_f32_dpp v76, v76, v76 quad_perm:[2,3,0,1] row_mask:0xf bank_mask:0xf
    s_nop 0
    v_add_f32_dpp v72, v72, v72 row_half_mirror row_mask:0xf bank_mask:0xf
    v_add_f32_dpp v76, v76, v76 row_half_mirror row_mask:0xf bank_mask:0xf
    v_mul_f32_e32 v72, 0x3ae38e39, v72
    v_mul_f32_e32 v76, 0x3ae38e39, v76
    v_fma_f32 v76, -v72, v72, v76
    v_pk_add_f32 v[192:193], v[192:193], v[72:73] op_sel_hi:[1,0] neg_lo:[0,1] neg_hi:[0,1]
    v_pk_add_f32 v[194:195], v[194:195], v[72:73] op_sel_hi:[1,0] neg_lo:[0,1] neg_hi:[0,1]
    v_pk_add_f32 v[196:197], v[196:197], v[72:73] op_sel_hi:[1,0] neg_lo:[0,1] neg_hi:[0,1]
    v_max_f32_e32 v76, 0, v76
    v_add_f32_e32 v76, 0x3727c5ac, v76
    v_mul_f32_e32 v76, 0x4091afa4, v76
    v_rsq_f32_e32 v74, v76
    v_pk_add_f32 v[198:199], v[198:199], v[72:73] op_sel_hi:[1,0] neg_lo:[0,1] neg_hi:[0,1]
    v_pk_add_f32 v[200:201], v[200:201], v[72:73] op_sel_hi:[1,0] neg_lo:[0,1] neg_hi:[0,1]
    v_pk_add_f32 v[202:203], v[202:203], v[72:73] op_sel_hi:[1,0] neg_lo:[0,1] neg_hi:[0,1]
    v_pk_mul_f32 v[192:193], v[192:193], v[74:75] op_sel_hi:[1,0]
    v_pk_mul_f32 v[194:195], v[194:195], v[74:75] op_sel_hi:[1,0]
    v_pk_mul_f32 v[196:197], v[196:197], v[74:75] op_sel_hi:[1,0]
    v_pk_mul_f32 v[198:199], v[198:199], v[74:75] op_sel_hi:[1,0]
    v_pk_mul_f32 v[200:201], v[200:201], v[74:75] op_sel_hi:[1,0]
    v_pk_mul_f32 v[202:203], v[202:203], v[74:75] op_sel_hi:[1,0]
    v_cvt_pk_bf16_f32 v144, v192, v193
    v_cvt_pk_bf16_f32 v145, v194, v195
    v_cvt_pk_bf16_f32 v146, v196, v197
    v_cvt_pk_bf16_f32 v147, v198, v199
    v_cvt_pk_bf16_f32 v180, v200, v201
    v_cvt_pk_bf16_f32 v181, v202, v203
    ds_write_b128 v227, v[144:147] offset:6144
    ds_write_b64 v228, v[180:181] offset:22528
    v_readlane_b32 s57, v11, 1
    s_waitcnt lgkmcnt(0)
    s_barrier
    ds_read_b64_tr_b16 v[88:89], v10 offset:14336
    ds_read_b64_tr_b16 v[90:91], v10 offset:14848
    ds_read_b64_tr_b16 v[92:93], v10 offset:15360
    ds_read_b64_tr_b16 v[94:95], v10 offset:15872
    s_waitcnt vmcnt(0)
    ds_read_b64_tr_b16 v[112:113], v2 offset:0
    ds_read_b64_tr_b16 v[114:115], v2 offset:1024
    ds_read_b64_tr_b16 v[116:117], v2 offset:2048
    ds_read_b64_tr_b16 v[118:119], v2 offset:3072
    ds_read_b64_tr_b16 v[96:97], v10 offset:6144
    ds_read_b64_tr_b16 v[98:99], v10 offset:6656
    ds_read_b64_tr_b16 v[100:101], v10 offset:7168
    ds_read_b64_tr_b16 v[102:103], v10 offset:7680
    v_mfma_f32_32x32x16_bf16 v[128:143], v[22:25], v[20:23], 0
    buffer_load_dwordx4 v8, s[28:31], s58 offen lds
    buffer_load_dwordx4 v8, s[28:31], s58 offen offset:1024 lds
    s_waitcnt lgkmcnt(4)
    v_mfma_f32_32x32x16_bf16 v[144:159], v[112:115], v[88:91], v[128:143]
    v_mfma_f32_32x32x16_bf16 v[144:159], v[116:119], v[92:95], v[144:159]
    buffer_load_ushort v22, v9, s[32:35], s57 offen
    buffer_load_short_d16_hi v30, v32, s[36:39], s69 offen
    s_mov_b32 s59, 2
    s_waitcnt lgkmcnt(0)
    s_nop 7
    v_pk_fma_f32 v[192:193], v[144:145], v[144:145], s[48:49] neg_lo:[1,0,0] neg_hi:[1,0,0]
    v_pk_fma_f32 v[194:195], v[146:147], v[146:147], s[48:49] neg_lo:[1,0,0] neg_hi:[1,0,0]
    v_pk_fma_f32 v[196:197], v[148:149], v[148:149], s[48:49] neg_lo:[1,0,0] neg_hi:[1,0,0]
    v_pk_fma_f32 v[198:199], v[150:151], v[150:151], s[48:49] neg_lo:[1,0,0] neg_hi:[1,0,0]
    v_pk_fma_f32 v[200:201], v[152:153], v[152:153], s[48:49] neg_lo:[1,0,0] neg_hi:[1,0,0]
    v_pk_fma_f32 v[202:203], v[154:155], v[154:155], s[48:49] neg_lo:[1,0,0] neg_hi:[1,0,0]
    v_pk_fma_f32 v[204:205], v[156:157], v[156:157], s[48:49] neg_lo:[1,0,0] neg_hi:[1,0,0]
    v_pk_fma_f32 v[206:207], v[158:159], v[158:159], s[48:49] neg_lo:[1,0,0] neg_hi:[1,0,0]
    v_pk_mul_f32 v[192:193], v[192:193], v[144:145]
    v_pk_mul_f32 v[194:195], v[194:195], v[146:147]
    v_pk_mul_f32 v[196:197], v[196:197], v[148:149]
    v_pk_mul_f32 v[198:199], v[198:199], v[150:151]
    v_pk_mul_f32 v[200:201], v[200:201], v[152:153]
    v_pk_mul_f32 v[202:203], v[202:203], v[154:155]
    v_pk_mul_f32 v[204:205], v[204:205], v[156:157]
    v_pk_mul_f32 v[206:207], v[206:207], v[158:159]
    s_mov_b32 s60, 18
    s_mov_b32 s62, 0
    s_setprio 0
.p2align 6
L_loopV:
    v_mfma_f32_32x32x16_bf16 v[160:175], v[112:115], v[96:99], v[128:143]
    v_exp_f32_e32 v192, v192
    v_exp_f32_e32 v193, v193
    v_exp_f32_e64 v194, v194
    v_mfma_f32_32x32x16_bf16 v[160:175], v[116:119], v[100:103], v[160:175]
    v_xor_b32_e32 v2, 64, v2
    v_exp_f32_e32 v195, v195
    v_exp_f32_e32 v196, v196
    v_exp_f32_e32 v197, v197
    v_smfmac_f32_32x32x32_bf16 v[40:55], v[120:123], v[208:215], v12
    v_exp_f32_e32 v198, v198
    v_exp_f32_e32 v199, v199
    v_exp_f32_e64 v200, v200
    v_smfmac_f32_32x32x32_bf16 v[40:55], v[124:127], v[216:223], v12
    v_exp_f32_e32 v201, v201
    v_exp_f32_e32 v202, v202
    v_exp_f32_e32 v203, v203
    v_exp_f32_e32 v204, v204
    v_exp_f32_e32 v205, v205
    v_exp_f32_e32 v206, v206
    v_exp_f32_e64 v207, v207
    v_pk_fma_f32 v[192:193], v[192:193], s[50:51], s[50:51]
    v_pk_fma_f32 v[194:195], v[194:195], s[50:51], s[50:51]
    v_pk_fma_f32 v[196:197], v[196:197], s[50:51], s[50:51]
    v_pk_fma_f32 v[198:199], v[198:199], s[50:51], s[50:51]
    v_pk_fma_f32 v[200:201], v[200:201], s[50:51], s[50:51]
    v_pk_fma_f32 v[202:203], v[202:203], s[50:51], s[50:51]
    v_pk_fma_f32 v[204:205], v[204:205], s[50:51], s[50:51]
    v_pk_fma_f32 v[206:207], v[206:207], s[50:51], s[50:51]
    s_waitcnt vmcnt(0)
    v_mfma_f32_32x32x16_bf16 v[128:143], v[22:25], v[20:23], 0
    s_setprio 2
    ds_read_b64_tr_b16 v[112:113], v2 offset:0
    ds_read_b64_tr_b16 v[114:115], v2 offset:1024
    ds_read_b64_tr_b16 v[116:117], v2 offset:2048
    ds_read_b64_tr_b16 v[118:119], v2 offset:3072
    ds_read_b64_tr_b16 v[120:121], v3 offset:0
    ds_read_b64_tr_b16 v[122:123], v3 offset:256
    ds_read_b64_tr_b16 v[124:125], v3 offset:1024
    ds_read_b64_tr_b16 v[126:127], v3 offset:1280
    s_setprio 0
    v_rcp_f32_e32 v192, v192
    v_rcp_f32_e32 v193, v193
    v_rcp_f32_e32 v194, v194
    v_rcp_f32_e32 v195, v195
    v_rcp_f32_e32 v196, v196
    v_rcp_f32_e32 v197, v197
    v_rcp_f32_e32 v198, v198
    v_rcp_f32_e32 v199, v199
    v_rcp_f32_e32 v200, v200
    v_rcp_f32_e32 v201, v201
    v_rcp_f32_e32 v202, v202
    v_rcp_f32_e32 v203, v203
    v_rcp_f32_e32 v204, v204
    v_rcp_f32_e32 v205, v205
    v_rcp_f32_e32 v206, v206
    v_rcp_f32_e64 v207, v207
    v_pk_mul_f32 v[192:193], v[192:193], v[144:145]
    v_pk_mul_f32 v[194:195], v[194:195], v[146:147]
    v_pk_mul_f32 v[196:197], v[196:197], v[148:149]
    v_pk_mul_f32 v[198:199], v[198:199], v[150:151]
    v_pk_mul_f32 v[200:201], v[200:201], v[152:153]
    v_pk_mul_f32 v[202:203], v[202:203], v[154:155]
    v_pk_mul_f32 v[204:205], v[204:205], v[156:157]
    v_pk_mul_f32 v[206:207], v[206:207], v[158:159]
    s_cmp_eq_u32 s59, s60
    s_cbranch_scc1 L_drainV
    v_pk_fma_f32 v[208:209], v[160:161], v[160:161], s[48:49] neg_lo:[1,0,0] neg_hi:[1,0,0]
    v_pk_fma_f32 v[210:211], v[162:163], v[162:163], s[48:49] neg_lo:[1,0,0] neg_hi:[1,0,0]
    v_pk_fma_f32 v[212:213], v[164:165], v[164:165], s[48:49] neg_lo:[1,0,0] neg_hi:[1,0,0]
    v_pk_fma_f32 v[214:215], v[166:167], v[166:167], s[48:49] neg_lo:[1,0,0] neg_hi:[1,0,0]
    v_pk_fma_f32 v[216:217], v[168:169], v[168:169], s[48:49] neg_lo:[1,0,0] neg_hi:[1,0,0]
    v_pk_fma_f32 v[218:219], v[170:171], v[170:171], s[48:49] neg_lo:[1,0,0] neg_hi:[1,0,0]
    v_pk_fma_f32 v[220:221], v[172:173], v[172:173], s[48:49] neg_lo:[1,0,0] neg_hi:[1,0,0]
    v_pk_fma_f32 v[222:223], v[174:175], v[174:175], s[48:49] neg_lo:[1,0,0] neg_hi:[1,0,0]
    v_pk_mul_f32 v[208:209], v[208:209], v[160:161]
    v_pk_mul_f32 v[210:211], v[210:211], v[162:163]
    v_pk_mul_f32 v[212:213], v[212:213], v[164:165]
    v_pk_mul_f32 v[214:215], v[214:215], v[166:167]
    v_pk_mul_f32 v[216:217], v[216:217], v[168:169]
    v_pk_mul_f32 v[218:219], v[218:219], v[170:171]
    v_pk_mul_f32 v[220:221], v[220:221], v[172:173]
    v_pk_mul_f32 v[222:223], v[222:223], v[174:175]
    s_waitcnt lgkmcnt(0)
    v_mfma_f32_32x32x16_bf16 v[144:159], v[112:115], v[88:91], v[128:143]
    s_mov_b32 m0, s65
    s_lshl_b32 s58, s57, 101
    buffer_load_dwordx4 v8, s[28:31], s58 offen lds
    buffer_load_dwordx4 v8, s[28:31], s58 offen offset:1024 lds
    v_readlane_b32 s57, v11, s59
    v_exp_f32_e32 v208, v208
    v_exp_f32_e32 v209, v209
    v_exp_f32_e64 v210, v210
    v_mfma_f32_32x32x16_bf16 v[144:159], v[116:119], v[92:95], v[144:159]
    s_mov_b32 m0, s64
    s_and_b32 s61, s57, 0xffffff80
    buffer_load_dwordx4 v4, s[24:27], s61 offen offset:0 lds
    buffer_load_dwordx4 v5, s[24:27], s61 offen offset:1024 lds
    buffer_load_dwordx4 v6, s[24:27], s61 offen offset:2048 lds
    buffer_load_dwordx4 v7, s[24:27], s61 offen offset:3072 lds
    buffer_load_ushort v22, v9, s[32:35], s57 offen
    s_add_u32 s59, s59, 1
    v_exp_f32_e32 v211, v211
    v_exp_f32_e32 v212, v212
    v_exp_f32_e64 v213, v213
    v_smfmac_f32_32x32x32_bf16 v[56:71], v[120:123], v[192:199], v12
    v_exp_f32_e32 v214, v214
    v_exp_f32_e32 v215, v215
    v_exp_f32_e64 v216, v216
    v_smfmac_f32_32x32x32_bf16 v[56:71], v[124:127], v[200:207], v12
    v_exp_f32_e32 v217, v217
    v_exp_f32_e32 v218, v218
    v_exp_f32_e32 v219, v219
    v_exp_f32_e32 v220, v220
    v_exp_f32_e32 v221, v221
    v_exp_f32_e32 v222, v222
    v_exp_f32_e64 v223, v223
    v_pk_fma_f32 v[208:209], v[208:209], s[50:51], s[50:51]
    v_pk_fma_f32 v[210:211], v[210:211], s[50:51], s[50:51]
    v_pk_fma_f32 v[212:213], v[212:213], s[50:51], s[50:51]
    v_pk_fma_f32 v[214:215], v[214:215], s[50:51], s[50:51]
    v_pk_fma_f32 v[216:217], v[216:217], s[50:51], s[50:51]
    v_pk_fma_f32 v[218:219], v[218:219], s[50:51], s[50:51]
    v_pk_fma_f32 v[220:221], v[220:221], s[50:51], s[50:51]
    v_pk_fma_f32 v[222:223], v[222:223], s[50:51], s[50:51]
    v_rcp_f32_e32 v208, v208
    v_rcp_f32_e32 v209, v209
    v_rcp_f32_e32 v210, v210
    v_rcp_f32_e32 v211, v211
    v_rcp_f32_e32 v212, v212
    v_rcp_f32_e32 v213, v213
    v_rcp_f32_e32 v214, v214
    v_rcp_f32_e32 v215, v215
    v_rcp_f32_e32 v216, v216
    v_rcp_f32_e32 v217, v217
    v_rcp_f32_e32 v218, v218
    v_rcp_f32_e32 v219, v219
    v_rcp_f32_e32 v220, v220
    v_rcp_f32_e32 v221, v221
    v_rcp_f32_e32 v222, v222
    v_rcp_f32_e32 v223, v223
    v_pk_mul_f32 v[208:209], v[208:209], v[160:161]
    v_pk_mul_f32 v[210:211], v[210:211], v[162:163]
    v_pk_mul_f32 v[212:213], v[212:213], v[164:165]
    v_pk_mul_f32 v[214:215], v[214:215], v[166:167]
    v_pk_mul_f32 v[216:217], v[216:217], v[168:169]
    v_pk_mul_f32 v[218:219], v[218:219], v[170:171]
    v_pk_mul_f32 v[220:221], v[220:221], v[172:173]
    v_pk_mul_f32 v[222:223], v[222:223], v[174:175]
    v_pk_fma_f32 v[192:193], v[144:145], v[144:145], s[48:49] neg_lo:[1,0,0] neg_hi:[1,0,0]
    v_pk_fma_f32 v[194:195], v[146:147], v[146:147], s[48:49] neg_lo:[1,0,0] neg_hi:[1,0,0]
    v_pk_fma_f32 v[196:197], v[148:149], v[148:149], s[48:49] neg_lo:[1,0,0] neg_hi:[1,0,0]
    v_pk_fma_f32 v[198:199], v[150:151], v[150:151], s[48:49] neg_lo:[1,0,0] neg_hi:[1,0,0]
    v_pk_fma_f32 v[200:201], v[152:153], v[152:153], s[48:49] neg_lo:[1,0,0] neg_hi:[1,0,0]
    v_pk_fma_f32 v[202:203], v[154:155], v[154:155], s[48:49] neg_lo:[1,0,0] neg_hi:[1,0,0]
    v_pk_fma_f32 v[204:205], v[156:157], v[156:157], s[48:49] neg_lo:[1,0,0] neg_hi:[1,0,0]
    v_pk_fma_f32 v[206:207], v[158:159], v[158:159], s[48:49] neg_lo:[1,0,0] neg_hi:[1,0,0]
    v_pk_mul_f32 v[192:193], v[192:193], v[144:145]
    v_pk_mul_f32 v[194:195], v[194:195], v[146:147]
    v_pk_mul_f32 v[196:197], v[196:197], v[148:149]
    v_pk_mul_f32 v[198:199], v[198:199], v[150:151]
    v_pk_mul_f32 v[200:201], v[200:201], v[152:153]
    v_pk_mul_f32 v[202:203], v[202:203], v[154:155]
    v_pk_mul_f32 v[204:205], v[204:205], v[156:157]
    v_pk_mul_f32 v[206:207], v[206:207], v[158:159]
    v_mfma_f32_32x32x16_bf16 v[160:175], v[112:115], v[96:99], v[128:143]
    v_exp_f32_e32 v192, v192
    v_exp_f32_e32 v193, v193
    v_exp_f32_e64 v194, v194
    v_mfma_f32_32x32x16_bf16 v[160:175], v[116:119], v[100:103], v[160:175]
    v_xor_b32_e32 v2, 64, v2
    v_exp_f32_e32 v195, v195
    v_exp_f32_e32 v196, v196
    v_exp_f32_e32 v197, v197
    v_smfmac_f32_32x32x32_bf16 v[40:55], v[120:123], v[208:215], v12
    v_exp_f32_e32 v198, v198
    v_exp_f32_e32 v199, v199
    v_exp_f32_e64 v200, v200
    v_smfmac_f32_32x32x32_bf16 v[40:55], v[124:127], v[216:223], v12
    v_exp_f32_e32 v201, v201
    v_exp_f32_e32 v202, v202
    v_exp_f32_e32 v203, v203
    v_exp_f32_e32 v204, v204
    v_exp_f32_e32 v205, v205
    v_exp_f32_e32 v206, v206
    v_exp_f32_e64 v207, v207
    v_pk_fma_f32 v[192:193], v[192:193], s[50:51], s[50:51]
    v_pk_fma_f32 v[194:195], v[194:195], s[50:51], s[50:51]
    v_pk_fma_f32 v[196:197], v[196:197], s[50:51], s[50:51]
    v_pk_fma_f32 v[198:199], v[198:199], s[50:51], s[50:51]
    v_pk_fma_f32 v[200:201], v[200:201], s[50:51], s[50:51]
    v_pk_fma_f32 v[202:203], v[202:203], s[50:51], s[50:51]
    v_pk_fma_f32 v[204:205], v[204:205], s[50:51], s[50:51]
    v_pk_fma_f32 v[206:207], v[206:207], s[50:51], s[50:51]
    s_waitcnt vmcnt(0)
    v_mfma_f32_32x32x16_bf16 v[128:143], v[22:25], v[20:23], 0
    s_setprio 2
    ds_read_b64_tr_b16 v[112:113], v2 offset:0
    ds_read_b64_tr_b16 v[114:115], v2 offset:1024
    ds_read_b64_tr_b16 v[116:117], v2 offset:2048
    ds_read_b64_tr_b16 v[118:119], v2 offset:3072
    ds_read_b64_tr_b16 v[120:121], v3 offset:0
    ds_read_b64_tr_b16 v[122:123], v3 offset:256
    ds_read_b64_tr_b16 v[124:125], v3 offset:1024
    ds_read_b64_tr_b16 v[126:127], v3 offset:1280
    s_setprio 0
    v_rcp_f32_e32 v192, v192
    v_rcp_f32_e32 v193, v193
    v_rcp_f32_e32 v194, v194
    v_rcp_f32_e32 v195, v195
    v_rcp_f32_e32 v196, v196
    v_rcp_f32_e32 v197, v197
    v_rcp_f32_e32 v198, v198
    v_rcp_f32_e32 v199, v199
    v_rcp_f32_e32 v200, v200
    v_rcp_f32_e32 v201, v201
    v_rcp_f32_e32 v202, v202
    v_rcp_f32_e32 v203, v203
    v_rcp_f32_e32 v204, v204
    v_rcp_f32_e32 v205, v205
    v_rcp_f32_e32 v206, v206
    v_rcp_f32_e64 v207, v207
    v_pk_mul_f32 v[192:193], v[192:193], v[144:145]
    v_pk_mul_f32 v[194:195], v[194:195], v[146:147]
    v_pk_mul_f32 v[196:197], v[196:197], v[148:149]
    v_pk_mul_f32 v[198:199], v[198:199], v[150:151]
    v_pk_mul_f32 v[200:201], v[200:201], v[152:153]
    v_pk_mul_f32 v[202:203], v[202:203], v[154:155]
    v_pk_mul_f32 v[204:205], v[204:205], v[156:157]
    v_pk_mul_f32 v[206:207], v[206:207], v[158:159]
    v_pk_fma_f32 v[208:209], v[160:161], v[160:161], s[48:49] neg_lo:[1,0,0] neg_hi:[1,0,0]
    v_pk_fma_f32 v[210:211], v[162:163], v[162:163], s[48:49] neg_lo:[1,0,0] neg_hi:[1,0,0]
    v_pk_fma_f32 v[212:213], v[164:165], v[164:165], s[48:49] neg_lo:[1,0,0] neg_hi:[1,0,0]
    v_pk_fma_f32 v[214:215], v[166:167], v[166:167], s[48:49] neg_lo:[1,0,0] neg_hi:[1,0,0]
    v_pk_fma_f32 v[216:217], v[168:169], v[168:169], s[48:49] neg_lo:[1,0,0] neg_hi:[1,0,0]
    v_pk_fma_f32 v[218:219], v[170:171], v[170:171], s[48:49] neg_lo:[1,0,0] neg_hi:[1,0,0]
    v_pk_fma_f32 v[220:221], v[172:173], v[172:173], s[48:49] neg_lo:[1,0,0] neg_hi:[1,0,0]
    v_pk_fma_f32 v[222:223], v[174:175], v[174:175], s[48:49] neg_lo:[1,0,0] neg_hi:[1,0,0]
    v_pk_mul_f32 v[208:209], v[208:209], v[160:161]
    v_pk_mul_f32 v[210:211], v[210:211], v[162:163]
    v_pk_mul_f32 v[212:213], v[212:213], v[164:165]
    v_pk_mul_f32 v[214:215], v[214:215], v[166:167]
    v_pk_mul_f32 v[216:217], v[216:217], v[168:169]
    v_pk_mul_f32 v[218:219], v[218:219], v[170:171]
    v_pk_mul_f32 v[220:221], v[220:221], v[172:173]
    v_pk_mul_f32 v[222:223], v[222:223], v[174:175]
    s_waitcnt lgkmcnt(0)
    v_mfma_f32_32x32x16_bf16 v[144:159], v[112:115], v[88:91], v[128:143]
    s_mov_b32 m0, s65
    s_lshl_b32 s58, s57, 101
    buffer_load_dwordx4 v8, s[28:31], s58 offen lds
    buffer_load_dwordx4 v8, s[28:31], s58 offen offset:1024 lds
    v_readlane_b32 s57, v11, s59
    v_exp_f32_e32 v208, v208
    v_exp_f32_e32 v209, v209
    v_exp_f32_e64 v210, v210
    v_mfma_f32_32x32x16_bf16 v[144:159], v[116:119], v[92:95], v[144:159]
    s_add_u32 s59, s59, 1
    buffer_load_ushort v22, v9, s[32:35], s57 offen
    v_exp_f32_e32 v211, v211
    v_exp_f32_e32 v212, v212
    v_exp_f32_e32 v213, v213
    v_smfmac_f32_32x32x32_bf16 v[56:71], v[120:123], v[192:199], v12
    v_exp_f32_e32 v214, v214
    v_exp_f32_e32 v215, v215
    v_exp_f32_e64 v216, v216
    v_smfmac_f32_32x32x32_bf16 v[56:71], v[124:127], v[200:207], v12
    v_exp_f32_e32 v217, v217
    v_exp_f32_e32 v218, v218
    v_exp_f32_e32 v219, v219
    v_exp_f32_e32 v220, v220
    v_exp_f32_e32 v221, v221
    v_exp_f32_e32 v222, v222
    v_exp_f32_e64 v223, v223
    v_pk_fma_f32 v[208:209], v[208:209], s[50:51], s[50:51]
    v_pk_fma_f32 v[210:211], v[210:211], s[50:51], s[50:51]
    v_pk_fma_f32 v[212:213], v[212:213], s[50:51], s[50:51]
    v_pk_fma_f32 v[214:215], v[214:215], s[50:51], s[50:51]
    v_pk_fma_f32 v[216:217], v[216:217], s[50:51], s[50:51]
    v_pk_fma_f32 v[218:219], v[218:219], s[50:51], s[50:51]
    v_pk_fma_f32 v[220:221], v[220:221], s[50:51], s[50:51]
    v_pk_fma_f32 v[222:223], v[222:223], s[50:51], s[50:51]
    v_rcp_f32_e32 v208, v208
    v_rcp_f32_e32 v209, v209
    v_rcp_f32_e32 v210, v210
    v_rcp_f32_e32 v211, v211
    v_rcp_f32_e32 v212, v212
    v_rcp_f32_e32 v213, v213
    v_rcp_f32_e32 v214, v214
    v_rcp_f32_e32 v215, v215
    v_rcp_f32_e32 v216, v216
    v_rcp_f32_e32 v217, v217
    v_rcp_f32_e32 v218, v218
    v_rcp_f32_e32 v219, v219
    v_rcp_f32_e32 v220, v220
    v_rcp_f32_e32 v221, v221
    v_rcp_f32_e32 v222, v222
    v_rcp_f32_e32 v223, v223
    v_pk_mul_f32 v[208:209], v[208:209], v[160:161]
    v_pk_mul_f32 v[210:211], v[210:211], v[162:163]
    v_pk_mul_f32 v[212:213], v[212:213], v[164:165]
    v_pk_mul_f32 v[214:215], v[214:215], v[166:167]
    v_pk_mul_f32 v[216:217], v[216:217], v[168:169]
    v_pk_mul_f32 v[218:219], v[218:219], v[170:171]
    v_pk_mul_f32 v[220:221], v[220:221], v[172:173]
    v_pk_mul_f32 v[222:223], v[222:223], v[174:175]
    v_pk_fma_f32 v[192:193], v[144:145], v[144:145], s[48:49] neg_lo:[1,0,0] neg_hi:[1,0,0]
    v_pk_fma_f32 v[194:195], v[146:147], v[146:147], s[48:49] neg_lo:[1,0,0] neg_hi:[1,0,0]
    v_pk_fma_f32 v[196:197], v[148:149], v[148:149], s[48:49] neg_lo:[1,0,0] neg_hi:[1,0,0]
    v_pk_fma_f32 v[198:199], v[150:151], v[150:151], s[48:49] neg_lo:[1,0,0] neg_hi:[1,0,0]
    v_pk_fma_f32 v[200:201], v[152:153], v[152:153], s[48:49] neg_lo:[1,0,0] neg_hi:[1,0,0]
    v_pk_fma_f32 v[202:203], v[154:155], v[154:155], s[48:49] neg_lo:[1,0,0] neg_hi:[1,0,0]
    v_pk_fma_f32 v[204:205], v[156:157], v[156:157], s[48:49] neg_lo:[1,0,0] neg_hi:[1,0,0]
    v_pk_fma_f32 v[206:207], v[158:159], v[158:159], s[48:49] neg_lo:[1,0,0] neg_hi:[1,0,0]
    v_pk_mul_f32 v[192:193], v[192:193], v[144:145]
    v_pk_mul_f32 v[194:195], v[194:195], v[146:147]
    v_pk_mul_f32 v[196:197], v[196:197], v[148:149]
    v_pk_mul_f32 v[198:199], v[198:199], v[150:151]
    v_pk_mul_f32 v[200:201], v[200:201], v[152:153]
    v_pk_mul_f32 v[202:203], v[202:203], v[154:155]
    v_pk_mul_f32 v[204:205], v[204:205], v[156:157]
    v_pk_mul_f32 v[206:207], v[206:207], v[158:159]
    s_branch L_loopV
L_drainV:
    s_setprio 2
    s_mov_b32 m0, s64
    s_waitcnt lgkmcnt(0)
    v_smfmac_f32_32x32x32_bf16 v[56:71], v[120:123], v[192:199], v12
    ds_read_b32 v34, v26 offset:64520
    v_smfmac_f32_32x32x32_bf16 v[56:71], v[124:127], v[200:207], v12
    ds_write_addtid_b32 v40 offset:0
    ds_write_addtid_b32 v41 offset:256
    ds_write_addtid_b32 v42 offset:512
    ds_write_addtid_b32 v43 offset:768
    ds_write_addtid_b32 v44 offset:1024
    ds_write_addtid_b32 v45 offset:1280
    ds_write_addtid_b32 v46 offset:1536
    ds_write_addtid_b32 v47 offset:1792
    ds_write_addtid_b32 v48 offset:2048
    ds_write_addtid_b32 v49 offset:2304
    ds_write_addtid_b32 v50 offset:2560
    ds_write_addtid_b32 v51 offset:2816
    ds_write_addtid_b32 v52 offset:3072
    ds_write_addtid_b32 v53 offset:3328
    ds_write_addtid_b32 v54 offset:3584
    ds_write_addtid_b32 v55 offset:3840
    ds_write_addtid_b32 v56 offset:4096
    ds_write_addtid_b32 v57 offset:4352
    ds_write_addtid_b32 v58 offset:4608
    ds_write_addtid_b32 v59 offset:4864
    ds_write_addtid_b32 v60 offset:5120
    ds_write_addtid_b32 v61 offset:5376
    ds_write_addtid_b32 v62 offset:5632
    ds_write_addtid_b32 v63 offset:5888
    s_waitcnt lgkmcnt(14)
L_chk:
    v_readfirstlane_b32 s67, v34
    s_nop 0
    s_cmp_ge_u32 s67, 4
    s_cbranch_scc1 L_chkv
    ds_read_b32 v34, v26 offset:64520
    s_waitcnt lgkmcnt(0)
    s_branch L_chk
L_chkv:
    s_cmp_eq_u32 s54, 7
    ds_write_addtid_b32 v64 offset:6144
    ds_write_addtid_b32 v65 offset:6400
    ds_write_addtid_b32 v66 offset:6656
    ds_write_addtid_b32 v67 offset:6912
    s_cbranch_scc1 L_epi
    ds_write_addtid_b32 v68 offset:7168
    ds_write_addtid_b32 v69 offset:7424
    ds_write_addtid_b32 v70 offset:7680
    ds_write_addtid_b32 v71 offset:7936
    s_branch L_epi
L_drainL:
    s_mov_b32 m0, s64
    ds_read_b32 v33, v26 offset:64524
    ds_write_addtid_b32 v56 offset:0
    ds_write_addtid_b32 v57 offset:256
    ds_write_addtid_b32 v58 offset:512
    ds_write_addtid_b32 v59 offset:768
    ds_write_addtid_b32 v60 offset:1024
    ds_write_addtid_b32 v61 offset:1280
    ds_write_addtid_b32 v62 offset:1536
    ds_write_addtid_b32 v63 offset:1792
    ds_write_addtid_b32 v64 offset:2048
    ds_write_addtid_b32 v65 offset:2304
    ds_write_addtid_b32 v66 offset:2560
    ds_write_addtid_b32 v67 offset:2816
    s_waitcnt lgkmcnt(12)
    v_smfmac_f32_32x32x32_bf16 v[40:55], v[120:123], v[192:199], v12
    ds_write_addtid_b32 v68 offset:3072
    ds_write_addtid_b32 v69 offset:3328
    ds_write_addtid_b32 v70 offset:3584
    ds_write_addtid_b32 v71 offset:3840
    v_smfmac_f32_32x32x32_bf16 v[40:55], v[124:127], v[200:207], v12
L_S4:
    v_readfirstlane_b32 s62, v33
    s_nop 0
    s_cmp_lg_u32 s62, 0
    s_cbranch_scc1 L_S4y
    ds_read_b32 v33, v26 offset:64524
    s_waitcnt lgkmcnt(0)
    s_branch L_S4
L_S4y:
    s_cmp_lg_u32 s62, 4
    s_cbranch_scc1 L_S4x
    buffer_load_dwordx4 v[72:75], v8, s[20:23], s52 offen offset:0 sc1
    buffer_load_dwordx4 v[76:79], v8, s[20:23], s52 offen offset:1024 sc1
    buffer_load_dwordx4 v[80:83], v8, s[20:23], s52 offen offset:2048 sc1
    buffer_load_dwordx4 v[84:87], v8, s[20:23], s52 offen offset:3072 sc1
L_S4x:
    s_nop 5
    ds_write_addtid_b32 v40 offset:4096
    ds_write_addtid_b32 v41 offset:4352
    ds_write_addtid_b32 v42 offset:4608
    ds_write_addtid_b32 v43 offset:4864
    ds_write_addtid_b32 v44 offset:5120
    ds_write_addtid_b32 v45 offset:5376
    ds_write_addtid_b32 v46 offset:5632
    ds_write_addtid_b32 v47 offset:5888
    ds_write_addtid_b32 v48 offset:6144
    ds_write_addtid_b32 v49 offset:6400
    ds_write_addtid_b32 v50 offset:6656
    ds_write_addtid_b32 v51 offset:6912
    ds_write_addtid_b32 v52 offset:7168
    ds_write_addtid_b32 v53 offset:7424
    ds_write_addtid_b32 v54 offset:7680
    ds_write_addtid_b32 v55 offset:7936
    s_cmp_eq_u32 s54, 7
L_epi:
    s_waitcnt lgkmcnt(0)
    s_barrier
    s_cbranch_scc0 L_skipr
    ds_write_addtid_b32 v68 offset:7168
    ds_write_addtid_b32 v69 offset:7424
    ds_write_addtid_b32 v70 offset:7680
    ds_write_addtid_b32 v71 offset:7936
L_skipr:
    ds_read_b128 v[40:43], v16 offset:0
    ds_read_b128 v[44:47], v16 offset:8192
    ds_read_b128 v[48:51], v16 offset:16384
    ds_read_b128 v[52:55], v16 offset:24576
    ds_read_b128 v[56:59], v15 offset:32768
    ds_read_b128 v[60:63], v15 offset:40960
    ds_read_b128 v[64:67], v15 offset:49152
    ds_read_b128 v[68:71], v15 offset:57344
    s_waitcnt lgkmcnt(6)
    v_pk_add_f32 v[40:41], v[40:41], v[44:45]
    v_pk_add_f32 v[42:43], v[42:43], v[46:47]
    s_waitcnt lgkmcnt(4)
    v_pk_add_f32 v[48:49], v[48:49], v[52:53]
    v_pk_add_f32 v[50:51], v[50:51], v[54:55]
    v_pk_add_f32 v[40:41], v[40:41], v[48:49]
    v_pk_add_f32 v[42:43], v[42:43], v[50:51]
    v_pk_add_f32 v[40:41], v[40:41], v[30:31] op_sel_hi:[1,0]
    v_pk_add_f32 v[42:43], v[42:43], v[30:31] op_sel_hi:[1,0]
    s_waitcnt lgkmcnt(2)
    v_pk_add_f32 v[56:57], v[56:57], v[60:61]
    v_pk_add_f32 v[58:59], v[58:59], v[62:63]
    v_pk_add_f32 v[40:41], v[40:41], v[56:57]
    v_pk_add_f32 v[42:43], v[42:43], v[58:59]
    s_waitcnt lgkmcnt(0)
    v_pk_add_f32 v[64:65], v[64:65], v[68:69]
    v_pk_add_f32 v[66:67], v[66:67], v[70:71]
    v_pk_add_f32 v[40:41], v[40:41], v[64:65]
    v_pk_add_f32 v[42:43], v[42:43], v[66:67]
    v_cvt_pk_bf16_f32 v44, v40, v41
    v_cvt_pk_bf16_f32 v45, v42, v43
    buffer_store_dwordx2 v[44:45], v18, s[40:43], s99 offen
    s_cmp_lg_u32 s62, 4
    s_cbranch_scc1 L_noE
    s_waitcnt vmcnt(1)
    v_pk_add_f32 v[72:73], v[72:73], v[76:77]
    v_pk_add_f32 v[74:75], v[74:75], v[78:79]
    v_pk_add_f32 v[80:81], v[80:81], v[84:85]
    v_pk_add_f32 v[82:83], v[82:83], v[86:87]
    v_pk_add_f32 v[72:73], v[72:73], v[80:81]
    v_pk_add_f32 v[74:75], v[74:75], v[82:83]
    v_pk_add_f32 v[72:73], v[72:73], v[30:31] op_sel_hi:[1,0]
    v_pk_add_f32 v[74:75], v[74:75], v[30:31] op_sel_hi:[1,0]
    v_cvt_pk_bf16_f32 v76, v72, v73
    v_cvt_pk_bf16_f32 v77, v74, v75
    buffer_store_dwordx2 v[76:77], v18, s[40:43], s101 offen
L_noE:
L_done:
    s_endpgm
.section .rodata,"a"
.p2align 6
.amdhsa_kernel standalone__mixer_token_mlp__sampling_kernel
  .amdhsa_next_free_vgpr 240
  .amdhsa_next_free_sgpr 102
  .amdhsa_accum_offset 240
  .amdhsa_group_segment_fixed_size 0
  .amdhsa_kernarg_size 64
  .amdhsa_user_sgpr_count 2
  .amdhsa_user_sgpr_kernarg_segment_ptr 1
  .amdhsa_system_sgpr_workgroup_id_x 1
.end_amdhsa_kernel
```
